```python
import torch

def _softmax(x, axis=-1):
    return torch.softmax(x, dim=axis)
def _gelu(x):
    return torch.nn.functional.gelu(x, approximate="tanh")
def _silu(x):
    return torch.nn.functional.silu(x)
def _sigmoid(x):
    return torch.sigmoid(x)
def _layernorm(x, axis=-1, eps=1e-5):
    m = x.mean(dim=axis, keepdim=True)
    v = x.var(dim=axis, keepdim=True, unbiased=False)
    return (x - m) / torch.sqrt(v + eps)
def _scatter_add(tgt, idx, src, axis=0):
    return tgt.clone().index_add_(axis, idx, src)
def _segment_sum(src, seg, n):
    out = torch.zeros((n,) + src.shape[1:], dtype=src.dtype)
    return out.index_add_(0, seg, src)
def _pad(x, pw):
    flat = tuple(v for pair in reversed(pw) for v in pair)
    return torch.nn.functional.pad(x, flat)

kernel_name = 'concat_heads__mha_block_cached__mha_block_cached__near_ridge'

def setup_inputs():

    _w = (lambda a: (lambda t: t.to(torch.bfloat16) if t.is_floating_point() else t)(torch.as_tensor(a)))
    def _A_setup():
        B, Sq, D = 8, 128, 576
        H, Sk, Dh = 32, 1024, 128
        return {
            "x": _w((lambda *s: torch.randn(*s, dtype=torch.bfloat16) * 0.8)(B, Sq, D)),
            "k_cache": _w((lambda *s: torch.randn(*s, dtype=torch.bfloat16) * 0.8)(B, H, Sk, Dh)),
            "v_cache": _w((lambda *s: torch.randn(*s, dtype=torch.bfloat16) * 0.05)(B, H, Sk, Dh)),
            "wq": _w((lambda *s: torch.randn(*s, dtype=torch.bfloat16) * 0.8)(D, H * Dh) * (D ** -0.5)),
            "wo": _w((lambda *s: torch.randn(*s, dtype=torch.bfloat16) * 0.05)(H * Dh, D) * ((H * Dh) ** -0.5)),
        }
    _A_in = _A_setup()

    def _B_setup():
        B, Sq, D = 8, 128, 576
        H, Sk, Dh = 32, 1024, 128
        return {
            "x": _w((lambda *s: torch.randn(*s, dtype=torch.bfloat16) * 0.8)(B, Sq, D)),
            "k_cache": _w((lambda *s: torch.randn(*s, dtype=torch.bfloat16) * 0.8)(B, H, Sk, Dh)),
            "v_cache": _w((lambda *s: torch.randn(*s, dtype=torch.bfloat16) * 0.05)(B, H, Sk, Dh)),
            "wq": _w((lambda *s: torch.randn(*s, dtype=torch.bfloat16) * 0.8)(D, H * Dh) * (D ** -0.5)),
            "wo": _w((lambda *s: torch.randn(*s, dtype=torch.bfloat16) * 0.05)(H * Dh, D) * ((H * Dh) ** -0.5)),
        }
    _B_in = _B_setup()

    return {
        "A_x": _A_in["x"],
        "A_k_cache": _A_in["k_cache"],
        "A_v_cache": _A_in["v_cache"],
        "A_wq": _A_in["wq"],
        "A_wo": _A_in["wo"],
        "B_x": _B_in["x"],
        "B_k_cache": _B_in["k_cache"],
        "B_v_cache": _B_in["v_cache"],
        "B_wq": _B_in["wq"],
        "B_wo": _B_in["wo"],
    }

def reference(A_x, A_k_cache, A_v_cache, A_wq, A_wo, B_x, B_k_cache, B_v_cache, B_wq, B_wo):
    def _A_ref(x, k_cache, v_cache, wq, wo):
        B, Sq, D = x.shape
        H, Dh = 32, 128
        q = (lambda x, *d: x.permute(*d))((x @ wq).reshape(B, Sq, H, Dh), 0, 2, 1, 3)
        scores = torch.einsum("bhqd,bhkd->bhqk", q, k_cache) * (Dh ** -0.5)
        p = _softmax(scores, axis=-1)
        o = torch.einsum("bhqk,bhkd->bhqd", p, v_cache)
        return (lambda x, *d: x.permute(*d))(o, 0, 2, 1, 3).reshape(B, Sq, H * Dh) @ wo

    def _B_ref(x, k_cache, v_cache, wq, wo):
        B, Sq, D = x.shape
        H, Dh = 32, 128
        q = (lambda x, *d: x.permute(*d))((x @ wq).reshape(B, Sq, H, Dh), 0, 2, 1, 3)
        scores = torch.einsum("bhqd,bhkd->bhqk", q, k_cache) * (Dh ** -0.5)
        p = _softmax(scores, axis=-1)
        o = torch.einsum("bhqk,bhkd->bhqd", p, v_cache)
        return (lambda x, *d: x.permute(*d))(o, 0, 2, 1, 3).reshape(B, Sq, H * Dh) @ wo

    a = _A_ref(A_x, A_k_cache, A_v_cache, A_wq, A_wo)
    b = _B_ref(B_x, B_k_cache, B_v_cache, B_wq, B_wo)
    return torch.concatenate([a, b], axis=-1)
```

```asm
; @launch kernel=attn_kernel grid=(256,1,1) block=(512,1,1) lds=163840
; @launch kernel=reduce_kernel grid=(576,1,1) block=(256,1,1) lds=0
.amdgcn_target "amdgcn-amd-amdhsa--gfx950"
.text
.globl attn_kernel
.p2align 8
.type attn_kernel,@function
attn_kernel:
s_cmp_ge_u32 s2, 256
s_cbranch_scc1 L_attn_done
s_load_dwordx2 s[38:39], s[0:1], 96
s_and_b32 s3, s2, 7
s_and_b32 s4, s3, 1
s_lshr_b32 s3, s3, 1
s_lshr_b32 s47, s2, 3
s_and_b32 s52, s47, 3
s_lshl_b32 s3, s3, 2
s_add_u32 s52, s52, s3
s_lshr_b32 s5, s47, 2
s_mul_i32 s3, s4, 40
s_add_u32 s0, s0, s3
s_addc_u32 s1, s1, 0
s_load_dwordx8 s[28:35], s[0:1], 0
s_load_dwordx2 s[36:37], s[0:1], 32
v_mov_b32 v221, v0
v_lshrrev_b32 v1, 6, v0
v_and_b32 v0, 63, v0
s_nop 0
v_readfirstlane_b32 s51, v1
s_nop 3
s_and_b32 s7, s51, 3
s_lshr_b32 s53, s51, 2
s_lshl_b32 s6, s52, 1
s_add_u32 s6, s6, s53
s_lshl_b32 s54, s53, 16
v_lshrrev_b32 v1, 4, v0
v_and_b32 v2, 15, v0
v_lshlrev_b32 v3, 2, v1
v_xor_b32 v3, v3, v2
v_xor_b32 v23, 0, v3
v_lshlrev_b32 v23, 4, v23
v_lshl_add_u32 v4, v1, 8, v23
v_lshl_add_u32 v18, v1, 13, v23
v_xor_b32 v23, 1, v3
v_lshlrev_b32 v23, 4, v23
v_lshl_add_u32 v5, v1, 8, v23
v_lshl_add_u32 v19, v1, 13, v23
v_xor_b32 v23, 2, v3
v_lshlrev_b32 v23, 4, v23
v_lshl_add_u32 v6, v1, 8, v23
v_lshl_add_u32 v20, v1, 13, v23
v_xor_b32 v23, 3, v3
v_lshlrev_b32 v23, 4, v23
v_lshl_add_u32 v7, v1, 8, v23
v_lshl_add_u32 v21, v1, 13, v23
v_lshrrev_b32 v22, 3, v0
v_mul_u32_u24 v22, 1152, v22
v_and_b32 v23, 7, v0
v_xor_b32 v23, v23, v1
v_lshl_add_u32 v200, v23, 4, v22
v_xor_b32 v23, 4, v23
v_lshl_add_u32 v201, v23, 4, v22
v_and_b32 v23, 7, v0
v_bfe_u32 v9, v0, 4, 1
v_lshlrev_b32 v9, 2, v9
v_xor_b32 v23, v23, v9
v_lshl_add_u32 v222, v23, 4, v22
v_and_b32 v23, 31, v0
v_lshrrev_b32 v22, 5, v0
v_and_b32 v8, 3, v23
v_lshlrev_b32 v8, 2, v8
v_bfe_u32 v9, v23, 2, 2
v_or_b32 v8, v8, v9
v_xor_b32 v8, v8, v22
v_lshlrev_b32 v8, 4, v8
v_lshl_add_u32 v8, v23, 8, v8
v_add_u32 v8, s54, v8
v_bfe_u32 v9, v23, 1, 3
v_xor_b32 v9, v9, v22
v_lshlrev_b32 v9, 4, v9
v_lshl_add_u32 v9, v23, 7, v9
s_lshl_b32 s3, s7, 12
v_add_u32 v202, s3, v9
v_xor_b32 v203, 32, v202
v_xor_b32 v204, 64, v202
v_xor_b32 v205, 96, v202
v_add_u32 v208, 114688, v202
v_add_u32 v209, 114688, v203
v_add_u32 v210, 114688, v204
v_add_u32 v211, 114688, v205
v_lshrrev_b32 v10, 2, v2
v_and_b32 v11, 1, v1
v_lshlrev_b32 v11, 1, v11
v_bfe_u32 v12, v2, 1, 1
v_or_b32 v11, v11, v12
v_and_b32 v12, 1, v2
v_lshlrev_b32 v12, 3, v12
v_add_u32 v12, s54, v12
v_xor_b32 v13, v11, v22
v_lshl_add_u32 v13, v10, 2, v13
v_lshl_add_u32 v13, v13, 4, v12
v_lshl_add_u32 v14, v22, 2, v10
v_lshl_add_u32 v9, v14, 8, v13
v_lshrrev_b32 v13, 1, v10
v_lshl_add_u32 v13, v13, 2, v11
v_lshl_add_u32 v13, v13, 4, v12
v_lshl_add_u32 v14, v22, 3, v10
v_lshl_add_u32 v223, v14, 7, v13
v_lshlrev_b32 v14, 1, v22
v_xor_b32 v13, v11, v14
v_lshl_add_u32 v13, v10, 2, v13
v_lshl_add_u32 v13, v13, 4, v12
v_lshl_add_u32 v14, v22, 3, v10
v_lshl_add_u32 v3, v14, 8, v13
v_xor_b32 v212, 0, v3
v_xor_b32 v213, 16, v3
v_xor_b32 v214, 64, v3
v_xor_b32 v215, 80, v3
v_xor_b32 v216, 128, v3
v_xor_b32 v217, 144, v3
v_xor_b32 v218, 192, v3
v_xor_b32 v219, 208, v3
v_xor_b32 v10, 0, v8
v_xor_b32 v11, 32, v8
v_xor_b32 v12, 64, v8
v_xor_b32 v13, 96, v8
v_xor_b32 v14, 128, v8
v_xor_b32 v15, 160, v8
v_xor_b32 v16, 192, v8
v_xor_b32 v17, 224, v8
s_waitcnt lgkmcnt(0)
s_mul_i32 s3, s5, 147456
s_add_u32 s20, s28, s3
s_addc_u32 s21, s29, 0
s_and_b32 s21, s21, 0xffff
s_mov_b32 s22, 147456
s_mov_b32 s23, 0x20000
s_lshl_b32 s3, s5, 5
s_add_u32 s3, s3, s6
s_lshl_b32 s3, s3, 18
s_add_u32 s8, s30, s3
s_addc_u32 s9, s31, 0
s_and_b32 s9, s9, 0xffff
s_mov_b32 s10, 262144
s_mov_b32 s11, 0x20000
s_add_u32 s12, s32, s3
s_addc_u32 s13, s33, 0
s_and_b32 s13, s13, 0xffff
s_mov_b32 s14, 262144
s_mov_b32 s15, 0x20000
s_mov_b32 s16, s34
s_and_b32 s17, s35, 0xffff
s_mov_b32 s18, 4718592
s_mov_b32 s19, 0x20000
s_mov_b32 s56, s36
s_and_b32 s57, s37, 0xffff
s_mov_b32 s58, 4718592
s_mov_b32 s59, 0x20000
s_lshl_b32 s3, s4, 3
s_add_u32 s3, s3, s5
s_lshl_b32 s3, s3, 4
s_add_u32 s3, s3, s52
s_mul_i32 s3, s3, 147456
s_mul_i32 s47, s7, 36864
s_add_u32 s3, s3, s47
s_add_u32 s24, s38, s3
s_addc_u32 s25, s39, 0
s_and_b32 s25, s25, 0xffff
s_mov_b32 s26, 36864
s_mov_b32 s27, 0x20000
s_lshl_b32 s44, s7, 12
s_add_u32 s55, s44, s54
s_mov_b32 s46, 0x3e0293ee
s_lshl_b32 s48, s7, 17
s_lshl_b32 s3, s6, 8
s_add_u32 s48, s48, s3
s_mul_i32 s49, s51, 18432
s_lshl_b32 s40, s51, 11
s_lshl_b32 s3, s52, 8
s_lshl_b32 s47, s7, 5
s_add_u32 s3, s3, s47
s_mul_i32 s60, s3, 1152
s_add_u32 s37, s60, 512
s_mul_i32 s3, s53, 640
s_add_u32 s60, s60, s3
s_lshr_b32 s61, s2, 3
s_and_b32 s63, s2, 7
s_lshr_b32 s63, s63, 1
s_mov_b32 s32, s28
s_and_b32 s33, s29, 0xffff
s_mov_b32 s34, 1179648
s_mov_b32 s35, 0x20000
s_mul_i32 s3, s61, 288
v_add_u32 v220, s3, v221
v_lshlrev_b32 v220, 7, v220
v_cmp_gt_u32 vcc, 288, v221
v_mov_b32 v23, 0x40000000
s_nop 1
v_cndmask_b32 v220, v23, v220, vcc
s_mul_i32 s3, s61, 18
v_lshrrev_b32 v22, 4, v221
v_add_u32 v22, s3, v22
v_lshlrev_b32 v22, 13, v22
v_and_b32 v206, 15, v221
v_lshl_add_u32 v22, v206, 7, v22
s_lshl_b32 s3, s63, 11
v_add_u32 v22, s3, v22
v_cndmask_b32 v22, v23, v22, vcc
v_lshlrev_b32 v221, 6, v0
s_add_u32 s3, s40, 131072
s_mov_b32 m0, s3
s_add_u32 s50, s49, 0
buffer_load_dwordx4 v200, s[20:23], s50 offen lds
s_add_u32 s3, s40, 132096
s_mov_b32 m0, s3
s_add_u32 s50, s49, 9216
buffer_load_dwordx4 v201, s[20:23], s50 offen lds
s_add_u32 s3, s55, 0
s_mov_b32 m0, s3
s_add_u32 s50, s48, 0
buffer_load_dwordx4 v18, s[16:19], s50 offen lds
s_add_u32 s3, s55, 1024
s_mov_b32 m0, s3
s_add_u32 s50, s48, 32768
buffer_load_dwordx4 v19, s[16:19], s50 offen lds
s_add_u32 s3, s55, 2048
s_mov_b32 m0, s3
s_add_u32 s50, s48, 65536
buffer_load_dwordx4 v20, s[16:19], s50 offen lds
s_add_u32 s3, s55, 3072
s_mov_b32 m0, s3
s_add_u32 s50, s48, 98304
buffer_load_dwordx4 v21, s[16:19], s50 offen lds
s_add_u32 s3, s40, 147456
s_mov_b32 m0, s3
s_add_u32 s50, s49, 128
buffer_load_dwordx4 v200, s[20:23], s50 offen lds
s_add_u32 s3, s40, 148480
s_mov_b32 m0, s3
s_add_u32 s50, s49, 9344
buffer_load_dwordx4 v201, s[20:23], s50 offen lds
s_add_u32 s3, s55, 16384
s_mov_b32 m0, s3
s_add_u32 s50, s48, 524288
buffer_load_dwordx4 v18, s[16:19], s50 offen lds
s_add_u32 s3, s55, 17408
s_mov_b32 m0, s3
s_add_u32 s50, s48, 557056
buffer_load_dwordx4 v19, s[16:19], s50 offen lds
s_add_u32 s3, s55, 18432
s_mov_b32 m0, s3
s_add_u32 s50, s48, 589824
buffer_load_dwordx4 v20, s[16:19], s50 offen lds
s_add_u32 s3, s55, 19456
s_mov_b32 m0, s3
s_add_u32 s50, s48, 622592
buffer_load_dwordx4 v21, s[16:19], s50 offen lds
s_add_u32 s3, s40, 49152
s_mov_b32 m0, s3
s_add_u32 s50, s49, 256
buffer_load_dwordx4 v200, s[20:23], s50 offen lds
s_add_u32 s3, s40, 50176
s_mov_b32 m0, s3
s_add_u32 s50, s49, 9472
buffer_load_dwordx4 v201, s[20:23], s50 offen lds
s_add_u32 s3, s40, 114688
s_mov_b32 m0, s3
s_add_u32 s50, s49, 384
buffer_load_dwordx4 v200, s[20:23], s50 offen lds
s_add_u32 s3, s40, 115712
s_mov_b32 m0, s3
s_add_u32 s50, s49, 9600
buffer_load_dwordx4 v201, s[20:23], s50 offen lds
buffer_load_dword v207, v220, s[32:35], 0 offen
buffer_load_dword v206, v22, s[16:19], 0 offen
s_waitcnt vmcnt(16)
s_barrier
ds_read_b128 v[88:91], v208 offset:16384
ds_read_b128 v[92:95], v209 offset:16384
ds_read_b128 v[96:99], v210 offset:16384
ds_read_b128 v[100:103], v211 offset:16384
s_waitcnt lgkmcnt(0)
s_waitcnt vmcnt(10)
s_barrier
ds_read_b64_tr_b16 v[168:169], v212 offset:0
ds_read_b64_tr_b16 v[170:171], v213 offset:1024
ds_read_b64_tr_b16 v[172:173], v214 offset:0
ds_read_b64_tr_b16 v[174:175], v215 offset:1024
ds_read_b64_tr_b16 v[176:177], v216 offset:0
ds_read_b64_tr_b16 v[178:179], v217 offset:1024
ds_read_b64_tr_b16 v[180:181], v218 offset:0
ds_read_b64_tr_b16 v[182:183], v219 offset:1024
ds_read_b64_tr_b16 v[184:185], v212 offset:4096
ds_read_b64_tr_b16 v[186:187], v213 offset:5120
s_waitcnt lgkmcnt(8)
v_mfma_f32_32x32x16_bf16 v[24:39], v[168:171], v[88:91], 0
s_add_u32 s3, s55, 32768
s_mov_b32 m0, s3
s_add_u32 s50, s48, 1048576
buffer_load_dwordx4 v18, s[16:19], s50 offen lds
ds_read_b64_tr_b16 v[188:189], v214 offset:4096
ds_read_b64_tr_b16 v[190:191], v215 offset:5120
s_waitcnt lgkmcnt(8)
v_mfma_f32_32x32x16_bf16 v[40:55], v[172:175], v[88:91], 0
s_add_u32 s3, s55, 33792
s_mov_b32 m0, s3
s_add_u32 s50, s48, 1081344
buffer_load_dwordx4 v19, s[16:19], s50 offen lds
ds_read_b64_tr_b16 v[192:193], v216 offset:4096
ds_read_b64_tr_b16 v[194:195], v217 offset:5120
s_waitcnt lgkmcnt(8)
v_mfma_f32_32x32x16_bf16 v[56:71], v[176:179], v[88:91], 0
s_add_u32 s3, s55, 34816
s_mov_b32 m0, s3
s_add_u32 s50, s48, 1114112
buffer_load_dwordx4 v20, s[16:19], s50 offen lds
ds_read_b64_tr_b16 v[196:197], v218 offset:4096
ds_read_b64_tr_b16 v[198:199], v219 offset:5120
s_waitcnt lgkmcnt(8)
v_mfma_f32_32x32x16_bf16 v[72:87], v[180:183], v[88:91], 0
s_add_u32 s3, s55, 35840
s_mov_b32 m0, s3
s_add_u32 s50, s48, 1146880
buffer_load_dwordx4 v21, s[16:19], s50 offen lds
ds_read_b128 v[104:107], v208 offset:32768
ds_read_b128 v[108:111], v209 offset:32768
ds_read_b128 v[112:115], v210 offset:32768
ds_read_b128 v[116:119], v211 offset:32768
ds_read_b64_tr_b16 v[168:169], v212 offset:8192
ds_read_b64_tr_b16 v[170:171], v213 offset:9216
s_waitcnt lgkmcnt(12)
v_mfma_f32_32x32x16_bf16 v[24:39], v[184:187], v[92:95], v[24:39]
s_add_u32 s3, s40, 131072
s_mov_b32 m0, s3
s_add_u32 s50, s49, 512
buffer_load_dwordx4 v200, s[20:23], s50 offen lds
ds_read_b64_tr_b16 v[172:173], v214 offset:8192
ds_read_b64_tr_b16 v[174:175], v215 offset:9216
s_waitcnt lgkmcnt(12)
v_mfma_f32_32x32x16_bf16 v[40:55], v[188:191], v[92:95], v[40:55]
s_add_u32 s3, s40, 132096
s_mov_b32 m0, s3
s_add_u32 s50, s49, 9728
buffer_load_dwordx4 v201, s[20:23], s50 offen lds
ds_read_b64_tr_b16 v[176:177], v216 offset:8192
ds_read_b64_tr_b16 v[178:179], v217 offset:9216
s_waitcnt lgkmcnt(12)
v_mfma_f32_32x32x16_bf16 v[56:71], v[192:195], v[92:95], v[56:71]
ds_read_b64_tr_b16 v[180:181], v218 offset:8192
ds_read_b64_tr_b16 v[182:183], v219 offset:9216
s_waitcnt lgkmcnt(12)
v_mfma_f32_32x32x16_bf16 v[72:87], v[196:199], v[92:95], v[72:87]
ds_read_b64_tr_b16 v[184:185], v212 offset:12288
ds_read_b64_tr_b16 v[186:187], v213 offset:13312
s_waitcnt lgkmcnt(8)
v_mfma_f32_32x32x16_bf16 v[24:39], v[168:171], v[96:99], v[24:39]
ds_read_b64_tr_b16 v[188:189], v214 offset:12288
ds_read_b64_tr_b16 v[190:191], v215 offset:13312
s_waitcnt lgkmcnt(8)
v_mfma_f32_32x32x16_bf16 v[40:55], v[172:175], v[96:99], v[40:55]
ds_read_b64_tr_b16 v[192:193], v216 offset:12288
ds_read_b64_tr_b16 v[194:195], v217 offset:13312
s_waitcnt lgkmcnt(8)
v_mfma_f32_32x32x16_bf16 v[56:71], v[176:179], v[96:99], v[56:71]
ds_read_b64_tr_b16 v[196:197], v218 offset:12288
ds_read_b64_tr_b16 v[198:199], v219 offset:13312
s_waitcnt lgkmcnt(8)
v_mfma_f32_32x32x16_bf16 v[72:87], v[180:183], v[96:99], v[72:87]
s_waitcnt lgkmcnt(0)
s_waitcnt vmcnt(10)
s_barrier
ds_read_b64_tr_b16 v[168:169], v212 offset:16384
ds_read_b64_tr_b16 v[170:171], v213 offset:17408
v_mfma_f32_32x32x16_bf16 v[24:39], v[184:187], v[100:103], v[24:39]
s_add_u32 s3, s55, 0
s_mov_b32 m0, s3
s_add_u32 s50, s48, 1572864
buffer_load_dwordx4 v18, s[16:19], s50 offen lds
ds_read_b64_tr_b16 v[172:173], v214 offset:16384
ds_read_b64_tr_b16 v[174:175], v215 offset:17408
v_mfma_f32_32x32x16_bf16 v[40:55], v[188:191], v[100:103], v[40:55]
s_add_u32 s3, s55, 1024
s_mov_b32 m0, s3
s_add_u32 s50, s48, 1605632
buffer_load_dwordx4 v19, s[16:19], s50 offen lds
ds_read_b64_tr_b16 v[176:177], v216 offset:16384
ds_read_b64_tr_b16 v[178:179], v217 offset:17408
v_mfma_f32_32x32x16_bf16 v[56:71], v[192:195], v[100:103], v[56:71]
s_add_u32 s3, s55, 2048
s_mov_b32 m0, s3
s_add_u32 s50, s48, 1638400
buffer_load_dwordx4 v20, s[16:19], s50 offen lds
ds_read_b64_tr_b16 v[180:181], v218 offset:16384
ds_read_b64_tr_b16 v[182:183], v219 offset:17408
v_mfma_f32_32x32x16_bf16 v[72:87], v[196:199], v[100:103], v[72:87]
s_add_u32 s3, s55, 3072
s_mov_b32 m0, s3
s_add_u32 s50, s48, 1671168
buffer_load_dwordx4 v21, s[16:19], s50 offen lds
ds_read_b64_tr_b16 v[184:185], v212 offset:20480
ds_read_b64_tr_b16 v[186:187], v213 offset:21504
s_waitcnt lgkmcnt(8)
v_mfma_f32_32x32x16_bf16 v[24:39], v[168:171], v[104:107], v[24:39]
s_add_u32 s3, s40, 147456
s_mov_b32 m0, s3
s_add_u32 s50, s49, 640
buffer_load_dwordx4 v200, s[20:23], s50 offen lds
ds_read_b64_tr_b16 v[188:189], v214 offset:20480
ds_read_b64_tr_b16 v[190:191], v215 offset:21504
s_waitcnt lgkmcnt(8)
v_mfma_f32_32x32x16_bf16 v[40:55], v[172:175], v[104:107], v[40:55]
s_add_u32 s3, s40, 148480
s_mov_b32 m0, s3
s_add_u32 s50, s49, 9856
buffer_load_dwordx4 v201, s[20:23], s50 offen lds
ds_read_b64_tr_b16 v[192:193], v216 offset:20480
ds_read_b64_tr_b16 v[194:195], v217 offset:21504
s_waitcnt lgkmcnt(8)
v_mfma_f32_32x32x16_bf16 v[56:71], v[176:179], v[104:107], v[56:71]
s_add_u32 s41, s44, 0
buffer_load_dword v23, v221, s[8:11], s41 offen
ds_read_b64_tr_b16 v[196:197], v218 offset:20480
ds_read_b64_tr_b16 v[198:199], v219 offset:21504
s_waitcnt lgkmcnt(8)
v_mfma_f32_32x32x16_bf16 v[72:87], v[180:183], v[104:107], v[72:87]
ds_read_b128 v[88:91], v202 offset:49152
ds_read_b128 v[92:95], v203 offset:49152
ds_read_b128 v[96:99], v204 offset:49152
ds_read_b128 v[100:103], v205 offset:49152
ds_read_b64_tr_b16 v[168:169], v212 offset:24576
ds_read_b64_tr_b16 v[170:171], v213 offset:25600
s_waitcnt lgkmcnt(12)
v_mfma_f32_32x32x16_bf16 v[24:39], v[184:187], v[108:111], v[24:39]
ds_read_b64_tr_b16 v[172:173], v214 offset:24576
ds_read_b64_tr_b16 v[174:175], v215 offset:25600
s_waitcnt lgkmcnt(12)
v_mfma_f32_32x32x16_bf16 v[40:55], v[188:191], v[108:111], v[40:55]
ds_read_b64_tr_b16 v[176:177], v216 offset:24576
ds_read_b64_tr_b16 v[178:179], v217 offset:25600
s_waitcnt lgkmcnt(12)
v_mfma_f32_32x32x16_bf16 v[56:71], v[192:195], v[108:111], v[56:71]
ds_read_b64_tr_b16 v[180:181], v218 offset:24576
ds_read_b64_tr_b16 v[182:183], v219 offset:25600
s_waitcnt lgkmcnt(12)
v_mfma_f32_32x32x16_bf16 v[72:87], v[196:199], v[108:111], v[72:87]
ds_read_b64_tr_b16 v[184:185], v212 offset:28672
ds_read_b64_tr_b16 v[186:187], v213 offset:29696
s_waitcnt lgkmcnt(8)
v_mfma_f32_32x32x16_bf16 v[24:39], v[168:171], v[112:115], v[24:39]
ds_read_b64_tr_b16 v[188:189], v214 offset:28672
ds_read_b64_tr_b16 v[190:191], v215 offset:29696
s_waitcnt lgkmcnt(8)
v_mfma_f32_32x32x16_bf16 v[40:55], v[172:175], v[112:115], v[40:55]
ds_read_b64_tr_b16 v[192:193], v216 offset:28672
ds_read_b64_tr_b16 v[194:195], v217 offset:29696
s_waitcnt lgkmcnt(8)
v_mfma_f32_32x32x16_bf16 v[56:71], v[176:179], v[112:115], v[56:71]
ds_read_b64_tr_b16 v[196:197], v218 offset:28672
ds_read_b64_tr_b16 v[198:199], v219 offset:29696
s_waitcnt lgkmcnt(8)
v_mfma_f32_32x32x16_bf16 v[72:87], v[180:183], v[112:115], v[72:87]
s_waitcnt lgkmcnt(0)
s_waitcnt vmcnt(9)
s_barrier
ds_read_b64_tr_b16 v[168:169], v212 offset:32768
ds_read_b64_tr_b16 v[170:171], v213 offset:33792
v_mfma_f32_32x32x16_bf16 v[24:39], v[184:187], v[116:119], v[24:39]
s_add_u32 s3, s55, 16384
s_mov_b32 m0, s3
s_add_u32 s50, s48, 2097152
buffer_load_dwordx4 v18, s[16:19], s50 offen lds
ds_read_b64_tr_b16 v[172:173], v214 offset:32768
ds_read_b64_tr_b16 v[174:175], v215 offset:33792
v_mfma_f32_32x32x16_bf16 v[40:55], v[188:191], v[116:119], v[40:55]
s_add_u32 s3, s55, 17408
s_mov_b32 m0, s3
s_add_u32 s50, s48, 2129920
buffer_load_dwordx4 v19, s[16:19], s50 offen lds
ds_read_b64_tr_b16 v[176:177], v216 offset:32768
ds_read_b64_tr_b16 v[178:179], v217 offset:33792
v_mfma_f32_32x32x16_bf16 v[56:71], v[192:195], v[116:119], v[56:71]
s_add_u32 s3, s55, 18432
s_mov_b32 m0, s3
s_add_u32 s50, s48, 2162688
buffer_load_dwordx4 v20, s[16:19], s50 offen lds
ds_read_b64_tr_b16 v[180:181], v218 offset:32768
ds_read_b64_tr_b16 v[182:183], v219 offset:33792
v_mfma_f32_32x32x16_bf16 v[72:87], v[196:199], v[116:119], v[72:87]
s_add_u32 s3, s55, 19456
s_mov_b32 m0, s3
s_add_u32 s50, s48, 2195456
buffer_load_dwordx4 v21, s[16:19], s50 offen lds
ds_read_b64_tr_b16 v[184:185], v212 offset:36864
ds_read_b64_tr_b16 v[186:187], v213 offset:37888
s_waitcnt lgkmcnt(8)
v_mfma_f32_32x32x16_bf16 v[24:39], v[168:171], v[88:91], v[24:39]
s_add_u32 s3, s40, 49152
s_mov_b32 m0, s3
s_add_u32 s50, s49, 768
buffer_load_dwordx4 v200, s[20:23], s50 offen lds
ds_read_b64_tr_b16 v[188:189], v214 offset:36864
ds_read_b64_tr_b16 v[190:191], v215 offset:37888
s_waitcnt lgkmcnt(8)
v_mfma_f32_32x32x16_bf16 v[40:55], v[172:175], v[88:91], v[40:55]
s_add_u32 s3, s40, 50176
s_mov_b32 m0, s3
s_add_u32 s50, s49, 9984
buffer_load_dwordx4 v201, s[20:23], s50 offen lds
ds_read_b64_tr_b16 v[192:193], v216 offset:36864
ds_read_b64_tr_b16 v[194:195], v217 offset:37888
s_waitcnt lgkmcnt(8)
v_mfma_f32_32x32x16_bf16 v[56:71], v[176:179], v[88:91], v[56:71]
s_add_u32 s41, s44, 16384
buffer_load_dword v23, v221, s[8:11], s41 offen
ds_read_b64_tr_b16 v[196:197], v218 offset:36864
ds_read_b64_tr_b16 v[198:199], v219 offset:37888
s_waitcnt lgkmcnt(8)
v_mfma_f32_32x32x16_bf16 v[72:87], v[180:183], v[88:91], v[72:87]
ds_read_b128 v[104:107], v208 offset:0
ds_read_b128 v[108:111], v209 offset:0
ds_read_b128 v[112:115], v210 offset:0
ds_read_b128 v[116:119], v211 offset:0
ds_read_b64_tr_b16 v[168:169], v212 offset:40960
ds_read_b64_tr_b16 v[170:171], v213 offset:41984
s_waitcnt lgkmcnt(12)
v_mfma_f32_32x32x16_bf16 v[24:39], v[184:187], v[92:95], v[24:39]
ds_read_b64_tr_b16 v[172:173], v214 offset:40960
ds_read_b64_tr_b16 v[174:175], v215 offset:41984
s_waitcnt lgkmcnt(12)
v_mfma_f32_32x32x16_bf16 v[40:55], v[188:191], v[92:95], v[40:55]
ds_read_b64_tr_b16 v[176:177], v216 offset:40960
ds_read_b64_tr_b16 v[178:179], v217 offset:41984
s_waitcnt lgkmcnt(12)
v_mfma_f32_32x32x16_bf16 v[56:71], v[192:195], v[92:95], v[56:71]
ds_read_b64_tr_b16 v[180:181], v218 offset:40960
ds_read_b64_tr_b16 v[182:183], v219 offset:41984
s_waitcnt lgkmcnt(12)
v_mfma_f32_32x32x16_bf16 v[72:87], v[196:199], v[92:95], v[72:87]
ds_read_b64_tr_b16 v[184:185], v212 offset:45056
ds_read_b64_tr_b16 v[186:187], v213 offset:46080
s_waitcnt lgkmcnt(8)
v_mfma_f32_32x32x16_bf16 v[24:39], v[168:171], v[96:99], v[24:39]
ds_read_b64_tr_b16 v[188:189], v214 offset:45056
ds_read_b64_tr_b16 v[190:191], v215 offset:46080
s_waitcnt lgkmcnt(8)
v_mfma_f32_32x32x16_bf16 v[40:55], v[172:175], v[96:99], v[40:55]
ds_read_b64_tr_b16 v[192:193], v216 offset:45056
ds_read_b64_tr_b16 v[194:195], v217 offset:46080
s_waitcnt lgkmcnt(8)
v_mfma_f32_32x32x16_bf16 v[56:71], v[176:179], v[96:99], v[56:71]
ds_read_b64_tr_b16 v[196:197], v218 offset:45056
ds_read_b64_tr_b16 v[198:199], v219 offset:46080
s_waitcnt lgkmcnt(8)
v_mfma_f32_32x32x16_bf16 v[72:87], v[180:183], v[96:99], v[72:87]
s_waitcnt lgkmcnt(0)
s_waitcnt vmcnt(10)
s_barrier
ds_read_b64_tr_b16 v[168:169], v212 offset:0
ds_read_b64_tr_b16 v[170:171], v213 offset:1024
v_mfma_f32_32x32x16_bf16 v[24:39], v[184:187], v[100:103], v[24:39]
s_add_u32 s3, s55, 32768
s_mov_b32 m0, s3
s_add_u32 s50, s48, 2621440
buffer_load_dwordx4 v18, s[16:19], s50 offen lds
ds_read_b64_tr_b16 v[172:173], v214 offset:0
ds_read_b64_tr_b16 v[174:175], v215 offset:1024
v_mfma_f32_32x32x16_bf16 v[40:55], v[188:191], v[100:103], v[40:55]
s_add_u32 s3, s55, 33792
s_mov_b32 m0, s3
s_add_u32 s50, s48, 2654208
buffer_load_dwordx4 v19, s[16:19], s50 offen lds
ds_read_b64_tr_b16 v[176:177], v216 offset:0
ds_read_b64_tr_b16 v[178:179], v217 offset:1024
v_mfma_f32_32x32x16_bf16 v[56:71], v[192:195], v[100:103], v[56:71]
s_add_u32 s3, s55, 34816
s_mov_b32 m0, s3
s_add_u32 s50, s48, 2686976
buffer_load_dwordx4 v20, s[16:19], s50 offen lds
ds_read_b64_tr_b16 v[180:181], v218 offset:0
ds_read_b64_tr_b16 v[182:183], v219 offset:1024
v_mfma_f32_32x32x16_bf16 v[72:87], v[196:199], v[100:103], v[72:87]
s_add_u32 s3, s55, 35840
s_mov_b32 m0, s3
s_add_u32 s50, s48, 2719744
buffer_load_dwordx4 v21, s[16:19], s50 offen lds
ds_read_b64_tr_b16 v[184:185], v212 offset:4096
ds_read_b64_tr_b16 v[186:187], v213 offset:5120
s_waitcnt lgkmcnt(8)
v_mfma_f32_32x32x16_bf16 v[24:39], v[168:171], v[104:107], v[24:39]
s_add_u32 s3, s40, 114688
s_mov_b32 m0, s3
s_add_u32 s50, s49, 896
buffer_load_dwordx4 v200, s[20:23], s50 offen lds
ds_read_b64_tr_b16 v[188:189], v214 offset:4096
ds_read_b64_tr_b16 v[190:191], v215 offset:5120
s_waitcnt lgkmcnt(8)
v_mfma_f32_32x32x16_bf16 v[40:55], v[172:175], v[104:107], v[40:55]
s_add_u32 s3, s40, 115712
s_mov_b32 m0, s3
s_add_u32 s50, s49, 10112
buffer_load_dwordx4 v201, s[20:23], s50 offen lds
ds_read_b64_tr_b16 v[192:193], v216 offset:4096
ds_read_b64_tr_b16 v[194:195], v217 offset:5120
s_waitcnt lgkmcnt(8)
v_mfma_f32_32x32x16_bf16 v[56:71], v[176:179], v[104:107], v[56:71]
ds_read_b64_tr_b16 v[196:197], v218 offset:4096
ds_read_b64_tr_b16 v[198:199], v219 offset:5120
s_waitcnt lgkmcnt(8)
v_mfma_f32_32x32x16_bf16 v[72:87], v[180:183], v[104:107], v[72:87]
ds_read_b128 v[88:91], v208 offset:16384
ds_read_b128 v[92:95], v209 offset:16384
ds_read_b128 v[96:99], v210 offset:16384
ds_read_b128 v[100:103], v211 offset:16384
ds_read_b64_tr_b16 v[168:169], v212 offset:8192
ds_read_b64_tr_b16 v[170:171], v213 offset:9216
s_waitcnt lgkmcnt(12)
v_mfma_f32_32x32x16_bf16 v[24:39], v[184:187], v[108:111], v[24:39]
ds_read_b64_tr_b16 v[172:173], v214 offset:8192
ds_read_b64_tr_b16 v[174:175], v215 offset:9216
s_waitcnt lgkmcnt(12)
v_mfma_f32_32x32x16_bf16 v[40:55], v[188:191], v[108:111], v[40:55]
ds_read_b64_tr_b16 v[176:177], v216 offset:8192
ds_read_b64_tr_b16 v[178:179], v217 offset:9216
s_waitcnt lgkmcnt(12)
v_mfma_f32_32x32x16_bf16 v[56:71], v[192:195], v[108:111], v[56:71]
ds_read_b64_tr_b16 v[180:181], v218 offset:8192
ds_read_b64_tr_b16 v[182:183], v219 offset:9216
s_waitcnt lgkmcnt(12)
v_mfma_f32_32x32x16_bf16 v[72:87], v[196:199], v[108:111], v[72:87]
ds_read_b64_tr_b16 v[184:185], v212 offset:12288
ds_read_b64_tr_b16 v[186:187], v213 offset:13312
s_waitcnt lgkmcnt(8)
v_mfma_f32_32x32x16_bf16 v[24:39], v[168:171], v[112:115], v[24:39]
ds_read_b64_tr_b16 v[188:189], v214 offset:12288
ds_read_b64_tr_b16 v[190:191], v215 offset:13312
s_waitcnt lgkmcnt(8)
v_mfma_f32_32x32x16_bf16 v[40:55], v[172:175], v[112:115], v[40:55]
ds_read_b64_tr_b16 v[192:193], v216 offset:12288
ds_read_b64_tr_b16 v[194:195], v217 offset:13312
s_waitcnt lgkmcnt(8)
v_mfma_f32_32x32x16_bf16 v[56:71], v[176:179], v[112:115], v[56:71]
ds_read_b64_tr_b16 v[196:197], v218 offset:12288
ds_read_b64_tr_b16 v[198:199], v219 offset:13312
s_waitcnt lgkmcnt(8)
v_mfma_f32_32x32x16_bf16 v[72:87], v[180:183], v[112:115], v[72:87]
s_waitcnt lgkmcnt(0)
s_waitcnt vmcnt(9)
s_barrier
ds_read_b64_tr_b16 v[168:169], v212 offset:16384
ds_read_b64_tr_b16 v[170:171], v213 offset:17408
v_mfma_f32_32x32x16_bf16 v[24:39], v[184:187], v[116:119], v[24:39]
s_add_u32 s3, s55, 0
s_mov_b32 m0, s3
s_add_u32 s50, s48, 3145728
buffer_load_dwordx4 v18, s[16:19], s50 offen lds
ds_read_b64_tr_b16 v[172:173], v214 offset:16384
ds_read_b64_tr_b16 v[174:175], v215 offset:17408
v_mfma_f32_32x32x16_bf16 v[40:55], v[188:191], v[116:119], v[40:55]
s_add_u32 s3, s55, 1024
s_mov_b32 m0, s3
s_add_u32 s50, s48, 3178496
buffer_load_dwordx4 v19, s[16:19], s50 offen lds
ds_read_b64_tr_b16 v[176:177], v216 offset:16384
ds_read_b64_tr_b16 v[178:179], v217 offset:17408
v_mfma_f32_32x32x16_bf16 v[56:71], v[192:195], v[116:119], v[56:71]
s_add_u32 s3, s55, 2048
s_mov_b32 m0, s3
s_add_u32 s50, s48, 3211264
buffer_load_dwordx4 v20, s[16:19], s50 offen lds
ds_read_b64_tr_b16 v[180:181], v218 offset:16384
ds_read_b64_tr_b16 v[182:183], v219 offset:17408
v_mfma_f32_32x32x16_bf16 v[72:87], v[196:199], v[116:119], v[72:87]
s_add_u32 s3, s55, 3072
s_mov_b32 m0, s3
s_add_u32 s50, s48, 3244032
buffer_load_dwordx4 v21, s[16:19], s50 offen lds
ds_read_b64_tr_b16 v[184:185], v212 offset:20480
ds_read_b64_tr_b16 v[186:187], v213 offset:21504
s_waitcnt lgkmcnt(8)
v_mfma_f32_32x32x16_bf16 v[24:39], v[168:171], v[88:91], v[24:39]
s_add_u32 s3, s40, 131072
s_mov_b32 m0, s3
s_add_u32 s50, s49, 1024
buffer_load_dwordx4 v200, s[20:23], s50 offen lds
ds_read_b64_tr_b16 v[188:189], v214 offset:20480
ds_read_b64_tr_b16 v[190:191], v215 offset:21504
s_waitcnt lgkmcnt(8)
v_mfma_f32_32x32x16_bf16 v[40:55], v[172:175], v[88:91], v[40:55]
s_add_u32 s3, s40, 132096
s_mov_b32 m0, s3
s_add_u32 s50, s49, 10240
buffer_load_dwordx4 v201, s[20:23], s50 offen lds
ds_read_b64_tr_b16 v[192:193], v216 offset:20480
ds_read_b64_tr_b16 v[194:195], v217 offset:21504
s_waitcnt lgkmcnt(8)
v_mfma_f32_32x32x16_bf16 v[56:71], v[176:179], v[88:91], v[56:71]
ds_read_b64_tr_b16 v[196:197], v218 offset:20480
ds_read_b64_tr_b16 v[198:199], v219 offset:21504
s_waitcnt lgkmcnt(8)
v_mfma_f32_32x32x16_bf16 v[72:87], v[180:183], v[88:91], v[72:87]
ds_read_b128 v[104:107], v208 offset:32768
ds_read_b128 v[108:111], v209 offset:32768
ds_read_b128 v[112:115], v210 offset:32768
ds_read_b128 v[116:119], v211 offset:32768
ds_read_b64_tr_b16 v[168:169], v212 offset:24576
ds_read_b64_tr_b16 v[170:171], v213 offset:25600
s_waitcnt lgkmcnt(12)
v_mfma_f32_32x32x16_bf16 v[24:39], v[184:187], v[92:95], v[24:39]
ds_read_b64_tr_b16 v[172:173], v214 offset:24576
ds_read_b64_tr_b16 v[174:175], v215 offset:25600
s_waitcnt lgkmcnt(12)
v_mfma_f32_32x32x16_bf16 v[40:55], v[188:191], v[92:95], v[40:55]
ds_read_b64_tr_b16 v[176:177], v216 offset:24576
ds_read_b64_tr_b16 v[178:179], v217 offset:25600
s_waitcnt lgkmcnt(12)
v_mfma_f32_32x32x16_bf16 v[56:71], v[192:195], v[92:95], v[56:71]
ds_read_b64_tr_b16 v[180:181], v218 offset:24576
ds_read_b64_tr_b16 v[182:183], v219 offset:25600
s_waitcnt lgkmcnt(12)
v_mfma_f32_32x32x16_bf16 v[72:87], v[196:199], v[92:95], v[72:87]
ds_read_b64_tr_b16 v[184:185], v212 offset:28672
ds_read_b64_tr_b16 v[186:187], v213 offset:29696
s_waitcnt lgkmcnt(8)
v_mfma_f32_32x32x16_bf16 v[24:39], v[168:171], v[96:99], v[24:39]
ds_read_b64_tr_b16 v[188:189], v214 offset:28672
ds_read_b64_tr_b16 v[190:191], v215 offset:29696
s_waitcnt lgkmcnt(8)
v_mfma_f32_32x32x16_bf16 v[40:55], v[172:175], v[96:99], v[40:55]
ds_read_b64_tr_b16 v[192:193], v216 offset:28672
ds_read_b64_tr_b16 v[194:195], v217 offset:29696
s_waitcnt lgkmcnt(8)
v_mfma_f32_32x32x16_bf16 v[56:71], v[176:179], v[96:99], v[56:71]
ds_read_b64_tr_b16 v[196:197], v218 offset:28672
ds_read_b64_tr_b16 v[198:199], v219 offset:29696
s_waitcnt lgkmcnt(8)
v_mfma_f32_32x32x16_bf16 v[72:87], v[180:183], v[96:99], v[72:87]
s_waitcnt lgkmcnt(0)
s_waitcnt vmcnt(8)
s_barrier
ds_read_b64_tr_b16 v[168:169], v212 offset:32768
ds_read_b64_tr_b16 v[170:171], v213 offset:33792
v_mfma_f32_32x32x16_bf16 v[24:39], v[184:187], v[100:103], v[24:39]
s_add_u32 s3, s55, 16384
s_mov_b32 m0, s3
s_add_u32 s50, s48, 3670016
buffer_load_dwordx4 v18, s[16:19], s50 offen lds
ds_read_b64_tr_b16 v[172:173], v214 offset:32768
ds_read_b64_tr_b16 v[174:175], v215 offset:33792
v_mfma_f32_32x32x16_bf16 v[40:55], v[188:191], v[100:103], v[40:55]
s_add_u32 s3, s55, 17408
s_mov_b32 m0, s3
s_add_u32 s50, s48, 3702784
buffer_load_dwordx4 v19, s[16:19], s50 offen lds
ds_read_b64_tr_b16 v[176:177], v216 offset:32768
ds_read_b64_tr_b16 v[178:179], v217 offset:33792
v_mfma_f32_32x32x16_bf16 v[56:71], v[192:195], v[100:103], v[56:71]
s_add_u32 s3, s55, 18432
s_mov_b32 m0, s3
s_add_u32 s50, s48, 3735552
buffer_load_dwordx4 v20, s[16:19], s50 offen lds
ds_read_b64_tr_b16 v[180:181], v218 offset:32768
ds_read_b64_tr_b16 v[182:183], v219 offset:33792
v_mfma_f32_32x32x16_bf16 v[72:87], v[196:199], v[100:103], v[72:87]
s_add_u32 s3, s55, 19456
s_mov_b32 m0, s3
s_add_u32 s50, s48, 3768320
buffer_load_dwordx4 v21, s[16:19], s50 offen lds
ds_read_b64_tr_b16 v[184:185], v212 offset:36864
ds_read_b64_tr_b16 v[186:187], v213 offset:37888
s_waitcnt lgkmcnt(8)
v_mfma_f32_32x32x16_bf16 v[24:39], v[168:171], v[104:107], v[24:39]
ds_read_b64_tr_b16 v[188:189], v214 offset:36864
ds_read_b64_tr_b16 v[190:191], v215 offset:37888
s_waitcnt lgkmcnt(8)
v_mfma_f32_32x32x16_bf16 v[40:55], v[172:175], v[104:107], v[40:55]
ds_read_b64_tr_b16 v[192:193], v216 offset:36864
ds_read_b64_tr_b16 v[194:195], v217 offset:37888
s_waitcnt lgkmcnt(8)
v_mfma_f32_32x32x16_bf16 v[56:71], v[176:179], v[104:107], v[56:71]
ds_read_b64_tr_b16 v[196:197], v218 offset:36864
ds_read_b64_tr_b16 v[198:199], v219 offset:37888
s_waitcnt lgkmcnt(8)
v_mfma_f32_32x32x16_bf16 v[72:87], v[180:183], v[104:107], v[72:87]
ds_read_b128 v[88:91], v202 offset:49152
ds_read_b128 v[92:95], v203 offset:49152
ds_read_b128 v[96:99], v204 offset:49152
ds_read_b128 v[100:103], v205 offset:49152
ds_read_b64_tr_b16 v[168:169], v212 offset:40960
ds_read_b64_tr_b16 v[170:171], v213 offset:41984
s_waitcnt lgkmcnt(12)
v_mfma_f32_32x32x16_bf16 v[24:39], v[184:187], v[108:111], v[24:39]
ds_read_b64_tr_b16 v[172:173], v214 offset:40960
ds_read_b64_tr_b16 v[174:175], v215 offset:41984
s_waitcnt lgkmcnt(12)
v_mfma_f32_32x32x16_bf16 v[40:55], v[188:191], v[108:111], v[40:55]
ds_read_b64_tr_b16 v[176:177], v216 offset:40960
ds_read_b64_tr_b16 v[178:179], v217 offset:41984
s_waitcnt lgkmcnt(12)
v_mfma_f32_32x32x16_bf16 v[56:71], v[192:195], v[108:111], v[56:71]
ds_read_b64_tr_b16 v[180:181], v218 offset:40960
ds_read_b64_tr_b16 v[182:183], v219 offset:41984
s_waitcnt lgkmcnt(12)
v_mfma_f32_32x32x16_bf16 v[72:87], v[196:199], v[108:111], v[72:87]
ds_read_b64_tr_b16 v[184:185], v212 offset:45056
ds_read_b64_tr_b16 v[186:187], v213 offset:46080
s_waitcnt lgkmcnt(8)
v_mfma_f32_32x32x16_bf16 v[24:39], v[168:171], v[112:115], v[24:39]
ds_read_b64_tr_b16 v[188:189], v214 offset:45056
ds_read_b64_tr_b16 v[190:191], v215 offset:46080
s_waitcnt lgkmcnt(8)
v_mfma_f32_32x32x16_bf16 v[40:55], v[172:175], v[112:115], v[40:55]
ds_read_b64_tr_b16 v[192:193], v216 offset:45056
ds_read_b64_tr_b16 v[194:195], v217 offset:46080
s_waitcnt lgkmcnt(8)
v_mfma_f32_32x32x16_bf16 v[56:71], v[176:179], v[112:115], v[56:71]
ds_read_b64_tr_b16 v[196:197], v218 offset:45056
ds_read_b64_tr_b16 v[198:199], v219 offset:46080
s_waitcnt lgkmcnt(8)
v_mfma_f32_32x32x16_bf16 v[72:87], v[180:183], v[112:115], v[72:87]
s_waitcnt lgkmcnt(0)
s_waitcnt vmcnt(6)
s_barrier
ds_read_b64_tr_b16 v[168:169], v212 offset:0
ds_read_b64_tr_b16 v[170:171], v213 offset:1024
v_mfma_f32_32x32x16_bf16 v[24:39], v[184:187], v[116:119], v[24:39]
s_add_u32 s3, s55, 32768
s_mov_b32 m0, s3
s_add_u32 s50, s48, 4194304
buffer_load_dwordx4 v18, s[16:19], s50 offen lds
ds_read_b64_tr_b16 v[172:173], v214 offset:0
ds_read_b64_tr_b16 v[174:175], v215 offset:1024
v_mfma_f32_32x32x16_bf16 v[40:55], v[188:191], v[116:119], v[40:55]
s_add_u32 s3, s55, 33792
s_mov_b32 m0, s3
s_add_u32 s50, s48, 4227072
buffer_load_dwordx4 v19, s[16:19], s50 offen lds
ds_read_b64_tr_b16 v[176:177], v216 offset:0
ds_read_b64_tr_b16 v[178:179], v217 offset:1024
v_mfma_f32_32x32x16_bf16 v[56:71], v[192:195], v[116:119], v[56:71]
s_add_u32 s3, s55, 34816
s_mov_b32 m0, s3
s_add_u32 s50, s48, 4259840
buffer_load_dwordx4 v20, s[16:19], s50 offen lds
ds_read_b64_tr_b16 v[180:181], v218 offset:0
ds_read_b64_tr_b16 v[182:183], v219 offset:1024
v_mfma_f32_32x32x16_bf16 v[72:87], v[196:199], v[116:119], v[72:87]
s_add_u32 s3, s55, 35840
s_mov_b32 m0, s3
s_add_u32 s50, s48, 4292608
buffer_load_dwordx4 v21, s[16:19], s50 offen lds
ds_read_b64_tr_b16 v[184:185], v212 offset:4096
ds_read_b64_tr_b16 v[186:187], v213 offset:5120
s_waitcnt lgkmcnt(8)
v_mfma_f32_32x32x16_bf16 v[24:39], v[168:171], v[88:91], v[24:39]
ds_read_b64_tr_b16 v[188:189], v214 offset:4096
ds_read_b64_tr_b16 v[190:191], v215 offset:5120
s_waitcnt lgkmcnt(8)
v_mfma_f32_32x32x16_bf16 v[40:55], v[172:175], v[88:91], v[40:55]
ds_read_b64_tr_b16 v[192:193], v216 offset:4096
ds_read_b64_tr_b16 v[194:195], v217 offset:5120
s_waitcnt lgkmcnt(8)
v_mfma_f32_32x32x16_bf16 v[56:71], v[176:179], v[88:91], v[56:71]
ds_read_b64_tr_b16 v[196:197], v218 offset:4096
ds_read_b64_tr_b16 v[198:199], v219 offset:5120
s_waitcnt lgkmcnt(8)
v_mfma_f32_32x32x16_bf16 v[72:87], v[180:183], v[88:91], v[72:87]
ds_read_b128 v[104:107], v208 offset:0
ds_read_b128 v[108:111], v209 offset:0
ds_read_b128 v[112:115], v210 offset:0
ds_read_b128 v[116:119], v211 offset:0
ds_read_b64_tr_b16 v[168:169], v212 offset:8192
ds_read_b64_tr_b16 v[170:171], v213 offset:9216
s_waitcnt lgkmcnt(12)
v_mfma_f32_32x32x16_bf16 v[24:39], v[184:187], v[92:95], v[24:39]
ds_read_b64_tr_b16 v[172:173], v214 offset:8192
ds_read_b64_tr_b16 v[174:175], v215 offset:9216
s_waitcnt lgkmcnt(12)
v_mfma_f32_32x32x16_bf16 v[40:55], v[188:191], v[92:95], v[40:55]
ds_read_b64_tr_b16 v[176:177], v216 offset:8192
ds_read_b64_tr_b16 v[178:179], v217 offset:9216
s_waitcnt lgkmcnt(12)
v_mfma_f32_32x32x16_bf16 v[56:71], v[192:195], v[92:95], v[56:71]
ds_read_b64_tr_b16 v[180:181], v218 offset:8192
ds_read_b64_tr_b16 v[182:183], v219 offset:9216
s_waitcnt lgkmcnt(12)
v_mfma_f32_32x32x16_bf16 v[72:87], v[196:199], v[92:95], v[72:87]
ds_read_b64_tr_b16 v[184:185], v212 offset:12288
ds_read_b64_tr_b16 v[186:187], v213 offset:13312
s_waitcnt lgkmcnt(8)
v_mfma_f32_32x32x16_bf16 v[24:39], v[168:171], v[96:99], v[24:39]
ds_read_b64_tr_b16 v[188:189], v214 offset:12288
ds_read_b64_tr_b16 v[190:191], v215 offset:13312
s_waitcnt lgkmcnt(8)
v_mfma_f32_32x32x16_bf16 v[40:55], v[172:175], v[96:99], v[40:55]
ds_read_b64_tr_b16 v[192:193], v216 offset:12288
ds_read_b64_tr_b16 v[194:195], v217 offset:13312
s_waitcnt lgkmcnt(8)
v_mfma_f32_32x32x16_bf16 v[56:71], v[176:179], v[96:99], v[56:71]
ds_read_b64_tr_b16 v[196:197], v218 offset:12288
ds_read_b64_tr_b16 v[198:199], v219 offset:13312
s_waitcnt lgkmcnt(8)
v_mfma_f32_32x32x16_bf16 v[72:87], v[180:183], v[96:99], v[72:87]
s_waitcnt lgkmcnt(0)
s_waitcnt vmcnt(4)
s_barrier
ds_read_b64_tr_b16 v[168:169], v212 offset:16384
ds_read_b64_tr_b16 v[170:171], v213 offset:17408
v_mfma_f32_32x32x16_bf16 v[24:39], v[184:187], v[100:103], v[24:39]
s_add_u32 s3, s55, 49152
s_mov_b32 m0, s3
s_add_u32 s50, s44, 0
buffer_load_dwordx4 v4, s[8:11], s50 offen offset:0 nt lds
ds_read_b64_tr_b16 v[172:173], v214 offset:16384
ds_read_b64_tr_b16 v[174:175], v215 offset:17408
v_mfma_f32_32x32x16_bf16 v[40:55], v[188:191], v[100:103], v[40:55]
buffer_load_dwordx4 v5, s[8:11], s50 offen offset:1024 nt lds
ds_read_b64_tr_b16 v[176:177], v216 offset:16384
ds_read_b64_tr_b16 v[178:179], v217 offset:17408
v_mfma_f32_32x32x16_bf16 v[56:71], v[192:195], v[100:103], v[56:71]
buffer_load_dwordx4 v6, s[8:11], s50 offen offset:2048 nt lds
ds_read_b64_tr_b16 v[180:181], v218 offset:16384
ds_read_b64_tr_b16 v[182:183], v219 offset:17408
v_mfma_f32_32x32x16_bf16 v[72:87], v[196:199], v[100:103], v[72:87]
buffer_load_dwordx4 v7, s[8:11], s50 offen offset:3072 nt lds
ds_read_b64_tr_b16 v[184:185], v212 offset:20480
ds_read_b64_tr_b16 v[186:187], v213 offset:21504
s_waitcnt lgkmcnt(8)
v_mfma_f32_32x32x16_bf16 v[24:39], v[168:171], v[104:107], v[24:39]
s_add_u32 s3, s55, 0
s_mov_b32 m0, s3
s_add_u32 s50, s44, 16384
buffer_load_dwordx4 v4, s[8:11], s50 offen offset:0 nt lds
ds_read_b64_tr_b16 v[188:189], v214 offset:20480
ds_read_b64_tr_b16 v[190:191], v215 offset:21504
s_waitcnt lgkmcnt(8)
v_mfma_f32_32x32x16_bf16 v[40:55], v[172:175], v[104:107], v[40:55]
buffer_load_dwordx4 v5, s[8:11], s50 offen offset:1024 nt lds
ds_read_b64_tr_b16 v[192:193], v216 offset:20480
ds_read_b64_tr_b16 v[194:195], v217 offset:21504
s_waitcnt lgkmcnt(8)
v_mfma_f32_32x32x16_bf16 v[56:71], v[176:179], v[104:107], v[56:71]
buffer_load_dwordx4 v6, s[8:11], s50 offen offset:2048 nt lds
ds_read_b64_tr_b16 v[196:197], v218 offset:20480
ds_read_b64_tr_b16 v[198:199], v219 offset:21504
s_waitcnt lgkmcnt(8)
v_mfma_f32_32x32x16_bf16 v[72:87], v[180:183], v[104:107], v[72:87]
buffer_load_dwordx4 v7, s[8:11], s50 offen offset:3072 nt lds
ds_read_b128 v[88:91], v208 offset:16384
ds_read_b128 v[92:95], v209 offset:16384
ds_read_b128 v[96:99], v210 offset:16384
ds_read_b128 v[100:103], v211 offset:16384
ds_read_b64_tr_b16 v[168:169], v212 offset:24576
ds_read_b64_tr_b16 v[170:171], v213 offset:25600
s_waitcnt lgkmcnt(12)
v_mfma_f32_32x32x16_bf16 v[24:39], v[184:187], v[108:111], v[24:39]
ds_read_b64_tr_b16 v[172:173], v214 offset:24576
ds_read_b64_tr_b16 v[174:175], v215 offset:25600
s_waitcnt lgkmcnt(12)
v_mfma_f32_32x32x16_bf16 v[40:55], v[188:191], v[108:111], v[40:55]
ds_read_b64_tr_b16 v[176:177], v216 offset:24576
ds_read_b64_tr_b16 v[178:179], v217 offset:25600
s_waitcnt lgkmcnt(12)
v_mfma_f32_32x32x16_bf16 v[56:71], v[192:195], v[108:111], v[56:71]
ds_read_b64_tr_b16 v[180:181], v218 offset:24576
ds_read_b64_tr_b16 v[182:183], v219 offset:25600
s_waitcnt lgkmcnt(12)
v_mfma_f32_32x32x16_bf16 v[72:87], v[196:199], v[108:111], v[72:87]
ds_read_b64_tr_b16 v[184:185], v212 offset:28672
ds_read_b64_tr_b16 v[186:187], v213 offset:29696
s_waitcnt lgkmcnt(8)
v_mfma_f32_32x32x16_bf16 v[24:39], v[168:171], v[112:115], v[24:39]
ds_read_b64_tr_b16 v[188:189], v214 offset:28672
ds_read_b64_tr_b16 v[190:191], v215 offset:29696
s_waitcnt lgkmcnt(8)
v_mfma_f32_32x32x16_bf16 v[40:55], v[172:175], v[112:115], v[40:55]
ds_read_b64_tr_b16 v[192:193], v216 offset:28672
ds_read_b64_tr_b16 v[194:195], v217 offset:29696
s_waitcnt lgkmcnt(8)
v_mfma_f32_32x32x16_bf16 v[56:71], v[176:179], v[112:115], v[56:71]
ds_read_b64_tr_b16 v[196:197], v218 offset:28672
ds_read_b64_tr_b16 v[198:199], v219 offset:29696
s_waitcnt lgkmcnt(8)
v_mfma_f32_32x32x16_bf16 v[72:87], v[180:183], v[112:115], v[72:87]
s_waitcnt lgkmcnt(0)
s_waitcnt vmcnt(8)
s_barrier
ds_read_b64_tr_b16 v[168:169], v212 offset:32768
ds_read_b64_tr_b16 v[170:171], v213 offset:33792
v_mfma_f32_32x32x16_bf16 v[24:39], v[184:187], v[116:119], v[24:39]
s_add_u32 s3, s55, 16384
s_mov_b32 m0, s3
s_add_u32 s50, s44, 0
buffer_load_dwordx4 v4, s[12:15], s50 offen offset:0 nt lds
ds_read_b64_tr_b16 v[172:173], v214 offset:32768
ds_read_b64_tr_b16 v[174:175], v215 offset:33792
v_mfma_f32_32x32x16_bf16 v[40:55], v[188:191], v[116:119], v[40:55]
buffer_load_dwordx4 v5, s[12:15], s50 offen offset:1024 nt lds
ds_read_b64_tr_b16 v[176:177], v216 offset:32768
ds_read_b64_tr_b16 v[178:179], v217 offset:33792
v_mfma_f32_32x32x16_bf16 v[56:71], v[192:195], v[116:119], v[56:71]
buffer_load_dwordx4 v6, s[12:15], s50 offen offset:2048 nt lds
ds_read_b64_tr_b16 v[180:181], v218 offset:32768
ds_read_b64_tr_b16 v[182:183], v219 offset:33792
v_mfma_f32_32x32x16_bf16 v[72:87], v[196:199], v[116:119], v[72:87]
buffer_load_dwordx4 v7, s[12:15], s50 offen offset:3072 nt lds
ds_read_b64_tr_b16 v[184:185], v212 offset:36864
ds_read_b64_tr_b16 v[186:187], v213 offset:37888
s_waitcnt lgkmcnt(8)
v_mfma_f32_32x32x16_bf16 v[24:39], v[168:171], v[88:91], v[24:39]
ds_read_b64_tr_b16 v[188:189], v214 offset:36864
ds_read_b64_tr_b16 v[190:191], v215 offset:37888
s_waitcnt lgkmcnt(8)
v_mfma_f32_32x32x16_bf16 v[40:55], v[172:175], v[88:91], v[40:55]
ds_read_b64_tr_b16 v[192:193], v216 offset:36864
ds_read_b64_tr_b16 v[194:195], v217 offset:37888
s_waitcnt lgkmcnt(8)
v_mfma_f32_32x32x16_bf16 v[56:71], v[176:179], v[88:91], v[56:71]
ds_read_b64_tr_b16 v[196:197], v218 offset:36864
ds_read_b64_tr_b16 v[198:199], v219 offset:37888
s_waitcnt lgkmcnt(8)
v_mfma_f32_32x32x16_bf16 v[72:87], v[180:183], v[88:91], v[72:87]
ds_read_b64_tr_b16 v[168:169], v212 offset:40960
ds_read_b64_tr_b16 v[170:171], v213 offset:41984
s_waitcnt lgkmcnt(8)
v_mfma_f32_32x32x16_bf16 v[24:39], v[184:187], v[92:95], v[24:39]
ds_read_b64_tr_b16 v[172:173], v214 offset:40960
ds_read_b64_tr_b16 v[174:175], v215 offset:41984
s_waitcnt lgkmcnt(8)
v_mfma_f32_32x32x16_bf16 v[40:55], v[188:191], v[92:95], v[40:55]
ds_read_b64_tr_b16 v[176:177], v216 offset:40960
ds_read_b64_tr_b16 v[178:179], v217 offset:41984
s_waitcnt lgkmcnt(8)
v_mfma_f32_32x32x16_bf16 v[56:71], v[192:195], v[92:95], v[56:71]
ds_read_b64_tr_b16 v[180:181], v218 offset:40960
ds_read_b64_tr_b16 v[182:183], v219 offset:41984
s_waitcnt lgkmcnt(8)
v_mfma_f32_32x32x16_bf16 v[72:87], v[196:199], v[92:95], v[72:87]
ds_read_b64_tr_b16 v[184:185], v212 offset:45056
ds_read_b64_tr_b16 v[186:187], v213 offset:46080
s_waitcnt lgkmcnt(8)
v_mfma_f32_32x32x16_bf16 v[24:39], v[168:171], v[96:99], v[24:39]
ds_read_b64_tr_b16 v[188:189], v214 offset:45056
ds_read_b64_tr_b16 v[190:191], v215 offset:46080
s_waitcnt lgkmcnt(8)
v_mfma_f32_32x32x16_bf16 v[40:55], v[172:175], v[96:99], v[40:55]
ds_read_b64_tr_b16 v[192:193], v216 offset:45056
ds_read_b64_tr_b16 v[194:195], v217 offset:46080
s_waitcnt lgkmcnt(8)
v_mfma_f32_32x32x16_bf16 v[56:71], v[176:179], v[96:99], v[56:71]
ds_read_b64_tr_b16 v[196:197], v218 offset:45056
ds_read_b64_tr_b16 v[198:199], v219 offset:46080
s_waitcnt lgkmcnt(8)
v_mfma_f32_32x32x16_bf16 v[72:87], v[180:183], v[96:99], v[72:87]
s_waitcnt lgkmcnt(0)
s_waitcnt vmcnt(8)
s_barrier
v_mfma_f32_32x32x16_bf16 v[24:39], v[184:187], v[100:103], v[24:39]
s_add_u32 s3, s55, 32768
s_mov_b32 m0, s3
s_add_u32 s50, s44, 32768
buffer_load_dwordx4 v4, s[8:11], s50 offen offset:0 nt lds
v_mfma_f32_32x32x16_bf16 v[40:55], v[188:191], v[100:103], v[40:55]
buffer_load_dwordx4 v5, s[8:11], s50 offen offset:1024 nt lds
v_mfma_f32_32x32x16_bf16 v[56:71], v[192:195], v[100:103], v[56:71]
buffer_load_dwordx4 v6, s[8:11], s50 offen offset:2048 nt lds
v_mfma_f32_32x32x16_bf16 v[72:87], v[196:199], v[100:103], v[72:87]
buffer_load_dwordx4 v7, s[8:11], s50 offen offset:3072 nt lds
s_nop 15
v_cvt_pk_bf16_f32 v224, v24, v25
v_cvt_pk_bf16_f32 v225, v26, v27
v_cvt_pk_bf16_f32 v226, v28, v29
v_cvt_pk_bf16_f32 v227, v30, v31
v_cvt_pk_bf16_f32 v228, v32, v33
v_cvt_pk_bf16_f32 v229, v34, v35
v_cvt_pk_bf16_f32 v230, v36, v37
v_cvt_pk_bf16_f32 v231, v38, v39
v_cvt_pk_bf16_f32 v232, v40, v41
v_cvt_pk_bf16_f32 v233, v42, v43
v_cvt_pk_bf16_f32 v234, v44, v45
v_cvt_pk_bf16_f32 v235, v46, v47
v_cvt_pk_bf16_f32 v236, v48, v49
v_cvt_pk_bf16_f32 v237, v50, v51
v_cvt_pk_bf16_f32 v238, v52, v53
v_cvt_pk_bf16_f32 v239, v54, v55
v_cvt_pk_bf16_f32 v240, v56, v57
v_cvt_pk_bf16_f32 v241, v58, v59
v_cvt_pk_bf16_f32 v242, v60, v61
v_cvt_pk_bf16_f32 v243, v62, v63
v_cvt_pk_bf16_f32 v244, v64, v65
v_cvt_pk_bf16_f32 v245, v66, v67
v_cvt_pk_bf16_f32 v246, v68, v69
v_cvt_pk_bf16_f32 v247, v70, v71
v_cvt_pk_bf16_f32 v248, v72, v73
v_cvt_pk_bf16_f32 v249, v74, v75
v_cvt_pk_bf16_f32 v250, v76, v77
v_cvt_pk_bf16_f32 v251, v78, v79
v_cvt_pk_bf16_f32 v252, v80, v81
v_cvt_pk_bf16_f32 v253, v82, v83
v_cvt_pk_bf16_f32 v254, v84, v85
v_cvt_pk_bf16_f32 v255, v86, v87
s_nop 1
v_permlane32_swap_b32 v224, v226
v_permlane32_swap_b32 v225, v227
v_permlane32_swap_b32 v228, v230
v_permlane32_swap_b32 v229, v231
v_permlane32_swap_b32 v232, v234
v_permlane32_swap_b32 v233, v235
v_permlane32_swap_b32 v236, v238
v_permlane32_swap_b32 v237, v239
v_permlane32_swap_b32 v240, v242
v_permlane32_swap_b32 v241, v243
v_permlane32_swap_b32 v244, v246
v_permlane32_swap_b32 v245, v247
v_permlane32_swap_b32 v248, v250
v_permlane32_swap_b32 v249, v251
v_permlane32_swap_b32 v252, v254
v_permlane32_swap_b32 v253, v255
v_xor_b32 v212, 0, v9
v_xor_b32 v213, 32, v9
v_xor_b32 v214, 64, v9
v_xor_b32 v215, 96, v9
v_xor_b32 v216, 128, v9
v_xor_b32 v217, 160, v9
v_xor_b32 v218, 192, v9
v_xor_b32 v219, 224, v9
v_mov_b32 v18, 0xff800000
v_mov_b32 v21, 0xff800000
v_mov_b32 v19, 0
s_add_u32 s43, s44, 16384
s_add_u32 s42, s44, 49152
s_mov_b32 s45, 0
s_nop 1
ds_read_b128 v[168:171], v10 offset:49152
ds_read_b128 v[172:175], v10 offset:57344
ds_read_b128 v[176:179], v11 offset:49152
ds_read_b128 v[180:183], v11 offset:57344
ds_read_b128 v[184:187], v12 offset:49152
ds_read_b128 v[188:191], v12 offset:57344
ds_read_b128 v[192:195], v13 offset:49152
s_waitcnt lgkmcnt(6)
v_mfma_f32_32x32x16_bf16 v[88:103], v[168:171], v[224:227], 0
v_mov_b32 v24, 0
v_mov_b32 v25, 0
v_mov_b32 v26, 0
v_mov_b32 v27, 0
ds_read_b128 v[196:199], v13 offset:57344
s_waitcnt lgkmcnt(6)
v_mfma_f32_32x32x16_bf16 v[104:119], v[172:175], v[224:227], 0
v_mov_b32 v28, 0
v_mov_b32 v29, 0
v_mov_b32 v30, 0
v_mov_b32 v31, 0
ds_read_b128 v[168:171], v14 offset:49152
s_waitcnt lgkmcnt(6)
v_mfma_f32_32x32x16_bf16 v[88:103], v[176:179], v[228:231], v[88:103]
v_mov_b32 v32, 0
v_mov_b32 v33, 0
v_mov_b32 v34, 0
v_mov_b32 v35, 0
ds_read_b128 v[172:175], v14 offset:57344
s_waitcnt lgkmcnt(6)
v_mfma_f32_32x32x16_bf16 v[104:119], v[180:183], v[228:231], v[104:119]
v_mov_b32 v36, 0
v_mov_b32 v37, 0
v_mov_b32 v38, 0
v_mov_b32 v39, 0
ds_read_b128 v[176:179], v15 offset:49152
s_waitcnt lgkmcnt(6)
v_mfma_f32_32x32x16_bf16 v[88:103], v[184:187], v[232:235], v[88:103]
v_mov_b32 v40, 0
v_mov_b32 v41, 0
v_mov_b32 v42, 0
v_mov_b32 v43, 0
ds_read_b128 v[180:183], v15 offset:57344
s_waitcnt lgkmcnt(6)
v_mfma_f32_32x32x16_bf16 v[104:119], v[188:191], v[232:235], v[104:119]
v_mov_b32 v44, 0
v_mov_b32 v45, 0
v_mov_b32 v46, 0
v_mov_b32 v47, 0
ds_read_b128 v[184:187], v16 offset:49152
s_waitcnt lgkmcnt(6)
v_mfma_f32_32x32x16_bf16 v[88:103], v[192:195], v[236:239], v[88:103]
v_mov_b32 v48, 0
v_mov_b32 v49, 0
v_mov_b32 v50, 0
v_mov_b32 v51, 0
ds_read_b128 v[188:191], v16 offset:57344
s_waitcnt lgkmcnt(6)
v_mfma_f32_32x32x16_bf16 v[104:119], v[196:199], v[236:239], v[104:119]
v_mov_b32 v52, 0
v_mov_b32 v53, 0
v_mov_b32 v54, 0
v_mov_b32 v55, 0
ds_read_b128 v[192:195], v17 offset:49152
s_waitcnt lgkmcnt(6)
v_mfma_f32_32x32x16_bf16 v[88:103], v[168:171], v[240:243], v[88:103]
v_mov_b32 v56, 0
v_mov_b32 v57, 0
v_mov_b32 v58, 0
v_mov_b32 v59, 0
ds_read_b128 v[196:199], v17 offset:57344
s_waitcnt lgkmcnt(6)
v_mfma_f32_32x32x16_bf16 v[104:119], v[172:175], v[240:243], v[104:119]
v_mov_b32 v60, 0
v_mov_b32 v61, 0
v_mov_b32 v62, 0
v_mov_b32 v63, 0
s_waitcnt lgkmcnt(5)
v_mfma_f32_32x32x16_bf16 v[88:103], v[176:179], v[244:247], v[88:103]
v_mov_b32 v64, 0
v_mov_b32 v65, 0
v_mov_b32 v66, 0
v_mov_b32 v67, 0
s_waitcnt lgkmcnt(4)
v_mfma_f32_32x32x16_bf16 v[104:119], v[180:183], v[244:247], v[104:119]
v_mov_b32 v68, 0
v_mov_b32 v69, 0
v_mov_b32 v70, 0
v_mov_b32 v71, 0
s_waitcnt lgkmcnt(0)
s_waitcnt vmcnt(8)
s_barrier
ds_read_b128 v[168:171], v10 offset:0
ds_read_b128 v[172:175], v10 offset:8192
ds_read_b128 v[176:179], v11 offset:0
v_mfma_f32_32x32x16_bf16 v[88:103], v[184:187], v[248:251], v[88:103]
s_add_u32 s3, s55, 49152
s_mov_b32 m0, s3
s_nop 0
buffer_load_dwordx4 v4, s[12:15], s43 offen offset:0 nt lds
v_mov_b32 v72, 0
v_mov_b32 v73, 0
v_mov_b32 v74, 0
v_mov_b32 v75, 0
ds_read_b128 v[180:183], v11 offset:8192
v_mfma_f32_32x32x16_bf16 v[104:119], v[188:191], v[248:251], v[104:119]
buffer_load_dwordx4 v5, s[12:15], s43 offen offset:1024 nt lds
v_mov_b32 v76, 0
v_mov_b32 v77, 0
v_mov_b32 v78, 0
v_mov_b32 v79, 0
v_mfma_f32_32x32x16_bf16 v[88:103], v[192:195], v[252:255], v[88:103]
buffer_load_dwordx4 v6, s[12:15], s43 offen offset:2048 nt lds
v_mov_b32 v80, 0
v_mov_b32 v81, 0
v_mov_b32 v82, 0
v_mov_b32 v83, 0
v_mfma_f32_32x32x16_bf16 v[104:119], v[196:199], v[252:255], v[104:119]
buffer_load_dwordx4 v7, s[12:15], s43 offen offset:3072 nt lds
s_add_u32 s43, s43, 16384
v_mov_b32 v84, 0
v_mov_b32 v85, 0
v_mov_b32 v86, 0
v_mov_b32 v87, 0
s_nop 7
s_nop 7
v_max3_f32 v200, v88, v89, v90
v_max3_f32 v201, v96, v97, v98
v_max3_f32 v202, v104, v105, v106
v_max3_f32 v203, v112, v113, v114
v_max3_f32 v200, v200, v91, v92
v_max3_f32 v201, v201, v99, v100
v_max3_f32 v202, v202, v107, v108
v_max3_f32 v203, v203, v115, v116
v_max3_f32 v200, v200, v93, v94
v_max3_f32 v201, v201, v101, v102
v_max3_f32 v202, v202, v109, v110
v_max3_f32 v203, v203, v117, v118
v_max_f32 v200, v200, v95
v_max_f32 v201, v201, v103
v_max_f32 v202, v202, v111
v_max_f32 v203, v203, v119
v_max3_f32 v200, v200, v201, v202
v_max_f32 v200, v200, v203
v_mov_b32 v201, v200
s_nop 1
v_permlane32_swap_b32 v200, v201
v_max_f32 v200, v200, v201
v_mul_f32 v204, s46, v200
v_cmp_gt_f32 vcc, v204, v21
L_loop:
s_cbranch_vccz L_nors_0
s_nop 15
v_max_f32 v205, v18, v204
v_sub_f32 v206, v18, v205
v_exp_f32 v20, v206
v_mov_b32 v18, v205
v_add_f32 v21, 0x41000000, v205
v_mul_f32 v19, v20, v19
v_mul_f32 v24, v20, v24
v_mul_f32 v25, v20, v25
v_mul_f32 v26, v20, v26
v_mul_f32 v27, v20, v27
v_mul_f32 v28, v20, v28
v_mul_f32 v29, v20, v29
v_mul_f32 v30, v20, v30
v_mul_f32 v31, v20, v31
v_mul_f32 v32, v20, v32
v_mul_f32 v33, v20, v33
v_mul_f32 v34, v20, v34
v_mul_f32 v35, v20, v35
v_mul_f32 v36, v20, v36
v_mul_f32 v37, v20, v37
v_mul_f32 v38, v20, v38
v_mul_f32 v39, v20, v39
v_mul_f32 v40, v20, v40
v_mul_f32 v41, v20, v41
v_mul_f32 v42, v20, v42
v_mul_f32 v43, v20, v43
v_mul_f32 v44, v20, v44
v_mul_f32 v45, v20, v45
v_mul_f32 v46, v20, v46
v_mul_f32 v47, v20, v47
v_mul_f32 v48, v20, v48
v_mul_f32 v49, v20, v49
v_mul_f32 v50, v20, v50
v_mul_f32 v51, v20, v51
v_mul_f32 v52, v20, v52
v_mul_f32 v53, v20, v53
v_mul_f32 v54, v20, v54
v_mul_f32 v55, v20, v55
v_mul_f32 v56, v20, v56
v_mul_f32 v57, v20, v57
v_mul_f32 v58, v20, v58
v_mul_f32 v59, v20, v59
v_mul_f32 v60, v20, v60
v_mul_f32 v61, v20, v61
v_mul_f32 v62, v20, v62
v_mul_f32 v63, v20, v63
v_mul_f32 v64, v20, v64
v_mul_f32 v65, v20, v65
v_mul_f32 v66, v20, v66
v_mul_f32 v67, v20, v67
v_mul_f32 v68, v20, v68
v_mul_f32 v69, v20, v69
v_mul_f32 v70, v20, v70
v_mul_f32 v71, v20, v71
v_mul_f32 v72, v20, v72
v_mul_f32 v73, v20, v73
v_mul_f32 v74, v20, v74
v_mul_f32 v75, v20, v75
v_mul_f32 v76, v20, v76
v_mul_f32 v77, v20, v77
v_mul_f32 v78, v20, v78
v_mul_f32 v79, v20, v79
v_mul_f32 v80, v20, v80
v_mul_f32 v81, v20, v81
v_mul_f32 v82, v20, v82
v_mul_f32 v83, v20, v83
v_mul_f32 v84, v20, v84
v_mul_f32 v85, v20, v85
v_mul_f32 v86, v20, v86
v_mul_f32 v87, v20, v87
L_nors_0:
ds_read_b128 v[184:187], v12 offset:0
ds_read_b128 v[188:191], v12 offset:8192
ds_read_b128 v[192:195], v13 offset:0
s_waitcnt lgkmcnt(6)
v_mfma_f32_32x32x16_bf16 v[120:135], v[168:171], v[224:227], 0
v_fma_f32 v88, v88, s46, -v18
v_fma_f32 v89, v89, s46, -v18
v_fma_f32 v90, v90, s46, -v18
v_fma_f32 v91, v91, s46, -v18
v_fma_f32 v92, v92, s46, -v18
v_fma_f32 v93, v93, s46, -v18
ds_read_b128 v[196:199], v13 offset:8192
s_waitcnt lgkmcnt(6)
v_mfma_f32_32x32x16_bf16 v[136:151], v[172:175], v[224:227], 0
v_fma_f32 v94, v94, s46, -v18
v_fma_f32 v95, v95, s46, -v18
v_exp_f32 v88, v88
v_exp_f32 v89, v89
v_exp_f32 v90, v90
ds_read_b128 v[168:171], v14 offset:0
s_waitcnt lgkmcnt(6)
v_mfma_f32_32x32x16_bf16 v[120:135], v[176:179], v[228:231], v[120:135]
v_exp_f32 v91, v91
v_fma_f32 v96, v96, s46, -v18
v_fma_f32 v97, v97, s46, -v18
v_fma_f32 v98, v98, s46, -v18
v_fma_f32 v99, v99, s46, -v18
ds_read_b128 v[172:175], v14 offset:8192
s_waitcnt lgkmcnt(6)
v_mfma_f32_32x32x16_bf16 v[136:151], v[180:183], v[228:231], v[136:151]
v_exp_f32 v92, v92
v_exp_f32 v93, v93
v_exp_f32 v94, v94
v_exp_f32 v95, v95
v_add_f32 v208, v88, v89
v_add_f32 v209, v90, v91
ds_read_b128 v[176:179], v15 offset:0
s_waitcnt lgkmcnt(6)
v_mfma_f32_32x32x16_bf16 v[120:135], v[184:187], v[232:235], v[120:135]
v_cvt_pk_bf16_f32 v152, v88, v89
v_cvt_pk_bf16_f32 v153, v90, v91
v_fma_f32 v100, v100, s46, -v18
v_fma_f32 v101, v101, s46, -v18
v_fma_f32 v102, v102, s46, -v18
ds_read_b128 v[180:183], v15 offset:8192
s_waitcnt lgkmcnt(6)
v_mfma_f32_32x32x16_bf16 v[136:151], v[188:191], v[232:235], v[136:151]
v_fma_f32 v103, v103, s46, -v18
v_exp_f32 v96, v96
v_exp_f32 v97, v97
v_exp_f32 v98, v98
v_exp_f32 v99, v99
ds_read_b128 v[184:187], v16 offset:0
s_waitcnt lgkmcnt(6)
v_mfma_f32_32x32x16_bf16 v[120:135], v[192:195], v[236:239], v[120:135]
v_add_f32 v208, v208, v92
v_add_f32 v209, v209, v94
v_add_f32 v208, v208, v93
v_add_f32 v209, v209, v95
v_cvt_pk_bf16_f32 v154, v92, v93
v_cvt_pk_bf16_f32 v155, v94, v95
ds_read_b128 v[188:191], v16 offset:8192
s_waitcnt lgkmcnt(6)
v_mfma_f32_32x32x16_bf16 v[136:151], v[196:199], v[236:239], v[136:151]
v_exp_f32 v100, v100
v_exp_f32 v101, v101
v_exp_f32 v102, v102
v_exp_f32 v103, v103
v_add_f32 v208, v208, v96
ds_read_b128 v[192:195], v17 offset:0
s_waitcnt lgkmcnt(6)
v_mfma_f32_32x32x16_bf16 v[120:135], v[168:171], v[240:243], v[120:135]
v_add_f32 v209, v209, v98
v_add_f32 v208, v208, v97
v_add_f32 v209, v209, v99
v_cvt_pk_bf16_f32 v156, v96, v97
v_cvt_pk_bf16_f32 v157, v98, v99
ds_read_b128 v[196:199], v17 offset:8192
s_waitcnt lgkmcnt(6)
v_mfma_f32_32x32x16_bf16 v[136:151], v[172:175], v[240:243], v[136:151]
v_add_f32 v208, v208, v100
v_add_f32 v209, v209, v102
v_add_f32 v208, v208, v101
v_add_f32 v209, v209, v103
v_cvt_pk_bf16_f32 v158, v100, v101
v_cvt_pk_bf16_f32 v159, v102, v103
s_waitcnt lgkmcnt(5)
v_mfma_f32_32x32x16_bf16 v[120:135], v[176:179], v[244:247], v[120:135]
v_add_f32 v208, v208, v209
v_add_f32 v19, v19, v208
v_fma_f32 v104, v104, s46, -v18
v_fma_f32 v105, v105, s46, -v18
v_fma_f32 v106, v106, s46, -v18
s_waitcnt lgkmcnt(4)
v_mfma_f32_32x32x16_bf16 v[136:151], v[180:183], v[244:247], v[136:151]
v_fma_f32 v107, v107, s46, -v18
v_fma_f32 v108, v108, s46, -v18
v_fma_f32 v109, v109, s46, -v18
v_fma_f32 v110, v110, s46, -v18
v_fma_f32 v111, v111, s46, -v18
s_waitcnt lgkmcnt(0)
s_waitcnt vmcnt(8)
s_barrier
ds_read_b64_tr_b16 v[168:169], v212 offset:16384
ds_read_b64_tr_b16 v[170:171], v213 offset:18432
ds_read_b64_tr_b16 v[172:173], v214 offset:16384
ds_read_b64_tr_b16 v[174:175], v215 offset:18432
ds_read_b64_tr_b16 v[176:177], v216 offset:16384
ds_read_b64_tr_b16 v[178:179], v217 offset:18432
v_mfma_f32_32x32x16_bf16 v[120:135], v[184:187], v[248:251], v[120:135]
s_add_u32 s3, s55, 0
s_mov_b32 m0, s3
s_nop 0
buffer_load_dwordx4 v4, s[8:11], s42 offen offset:0 nt lds
v_exp_f32 v104, v104
v_exp_f32 v105, v105
v_exp_f32 v106, v106
v_exp_f32 v107, v107
v_fma_f32 v112, v112, s46, -v18
v_fma_f32 v113, v113, s46, -v18
ds_read_b64_tr_b16 v[180:181], v218 offset:16384
ds_read_b64_tr_b16 v[182:183], v219 offset:18432
v_mfma_f32_32x32x16_bf16 v[136:151], v[188:191], v[248:251], v[136:151]
buffer_load_dwordx4 v5, s[8:11], s42 offen offset:1024 nt lds
v_fma_f32 v114, v114, s46, -v18
v_fma_f32 v115, v115, s46, -v18
v_exp_f32 v108, v108
v_exp_f32 v109, v109
v_exp_f32 v110, v110
ds_read_b64_tr_b16 v[184:185], v212 offset:20480
ds_read_b64_tr_b16 v[186:187], v213 offset:22528
v_mfma_f32_32x32x16_bf16 v[120:135], v[192:195], v[252:255], v[120:135]
buffer_load_dwordx4 v6, s[8:11], s42 offen offset:2048 nt lds
v_exp_f32 v111, v111
v_add_f32 v210, v104, v105
v_add_f32 v211, v106, v107
v_cvt_pk_bf16_f32 v160, v104, v105
v_cvt_pk_bf16_f32 v161, v106, v107
ds_read_b64_tr_b16 v[188:189], v214 offset:20480
ds_read_b64_tr_b16 v[190:191], v215 offset:22528
v_mfma_f32_32x32x16_bf16 v[136:151], v[196:199], v[252:255], v[136:151]
buffer_load_dwordx4 v7, s[8:11], s42 offen offset:3072 nt lds
s_add_u32 s42, s42, 16384
ds_read_b64_tr_b16 v[192:193], v216 offset:20480
ds_read_b64_tr_b16 v[194:195], v217 offset:22528
s_waitcnt lgkmcnt(12)
v_mfma_f32_32x32x16_bf16 v[24:39], v[168:171], v[152:155], v[24:39]
v_fma_f32 v116, v116, s46, -v18
v_fma_f32 v117, v117, s46, -v18
v_fma_f32 v118, v118, s46, -v18
v_fma_f32 v119, v119, s46, -v18
v_exp_f32 v112, v112
ds_read_b64_tr_b16 v[196:197], v218 offset:20480
ds_read_b64_tr_b16 v[198:199], v219 offset:22528
s_waitcnt lgkmcnt(12)
v_mfma_f32_32x32x16_bf16 v[40:55], v[172:175], v[152:155], v[40:55]
v_exp_f32 v113, v113
v_exp_f32 v114, v114
v_exp_f32 v115, v115
v_add_f32 v210, v210, v108
v_add_f32 v211, v211, v110
ds_read_b64_tr_b16 v[168:169], v212 offset:24576
ds_read_b64_tr_b16 v[170:171], v213 offset:26624
s_waitcnt lgkmcnt(12)
v_mfma_f32_32x32x16_bf16 v[56:71], v[176:179], v[152:155], v[56:71]
v_add_f32 v210, v210, v109
v_add_f32 v211, v211, v111
v_cvt_pk_bf16_f32 v162, v108, v109
v_cvt_pk_bf16_f32 v163, v110, v111
ds_read_b64_tr_b16 v[172:173], v214 offset:24576
ds_read_b64_tr_b16 v[174:175], v215 offset:26624
s_waitcnt lgkmcnt(12)
v_mfma_f32_32x32x16_bf16 v[72:87], v[180:183], v[152:155], v[72:87]
v_exp_f32 v116, v116
v_exp_f32 v117, v117
v_exp_f32 v118, v118
v_exp_f32 v119, v119
v_add_f32 v210, v210, v112
ds_read_b64_tr_b16 v[176:177], v216 offset:24576
ds_read_b64_tr_b16 v[178:179], v217 offset:26624
s_waitcnt lgkmcnt(12)
v_mfma_f32_32x32x16_bf16 v[24:39], v[184:187], v[156:159], v[24:39]
v_add_f32 v211, v211, v114
v_add_f32 v210, v210, v113
v_add_f32 v211, v211, v115
v_cvt_pk_bf16_f32 v164, v112, v113
ds_read_b64_tr_b16 v[180:181], v218 offset:24576
ds_read_b64_tr_b16 v[182:183], v219 offset:26624
s_waitcnt lgkmcnt(12)
v_mfma_f32_32x32x16_bf16 v[40:55], v[188:191], v[156:159], v[40:55]
v_cvt_pk_bf16_f32 v165, v114, v115
v_add_f32 v210, v210, v116
v_add_f32 v211, v211, v118
v_add_f32 v210, v210, v117
v_add_f32 v211, v211, v119
ds_read_b64_tr_b16 v[184:185], v212 offset:28672
ds_read_b64_tr_b16 v[186:187], v213 offset:30720
s_waitcnt lgkmcnt(12)
v_mfma_f32_32x32x16_bf16 v[56:71], v[192:195], v[156:159], v[56:71]
v_cvt_pk_bf16_f32 v166, v116, v117
v_cvt_pk_bf16_f32 v167, v118, v119
v_add_f32 v210, v210, v211
v_add_f32 v19, v19, v210
ds_read_b64_tr_b16 v[188:189], v214 offset:28672
ds_read_b64_tr_b16 v[190:191], v215 offset:30720
s_waitcnt lgkmcnt(12)
v_mfma_f32_32x32x16_bf16 v[72:87], v[196:199], v[156:159], v[72:87]
ds_read_b64_tr_b16 v[192:193], v216 offset:28672
ds_read_b64_tr_b16 v[194:195], v217 offset:30720
s_waitcnt lgkmcnt(12)
v_mfma_f32_32x32x16_bf16 v[24:39], v[168:171], v[160:163], v[24:39]
v_max3_f32 v200, v120, v121, v122
v_max3_f32 v201, v128, v129, v130
v_max3_f32 v202, v136, v137, v138
ds_read_b64_tr_b16 v[196:197], v218 offset:28672
ds_read_b64_tr_b16 v[198:199], v219 offset:30720
s_waitcnt lgkmcnt(12)
v_mfma_f32_32x32x16_bf16 v[40:55], v[172:175], v[160:163], v[40:55]
v_max3_f32 v203, v144, v145, v146
v_max3_f32 v200, v200, v123, v124
v_max3_f32 v201, v201, v131, v132
s_waitcnt lgkmcnt(10)
v_mfma_f32_32x32x16_bf16 v[56:71], v[176:179], v[160:163], v[56:71]
v_max3_f32 v202, v202, v139, v140
v_max3_f32 v203, v203, v147, v148
v_max3_f32 v200, v200, v125, v126
s_waitcnt lgkmcnt(8)
v_mfma_f32_32x32x16_bf16 v[72:87], v[180:183], v[160:163], v[72:87]
v_max3_f32 v201, v201, v133, v134
v_max3_f32 v202, v202, v141, v142
v_max3_f32 v203, v203, v149, v150
s_waitcnt lgkmcnt(0)
s_waitcnt vmcnt(8)
s_barrier
ds_read_b128 v[168:171], v10 offset:32768
ds_read_b128 v[172:175], v10 offset:40960
ds_read_b128 v[176:179], v11 offset:32768
v_mfma_f32_32x32x16_bf16 v[24:39], v[184:187], v[164:167], v[24:39]
s_add_u32 s3, s55, 16384
s_mov_b32 m0, s3
s_nop 0
buffer_load_dwordx4 v4, s[12:15], s43 offen offset:0 nt lds
v_max_f32 v200, v200, v127
v_max_f32 v201, v201, v135
v_max_f32 v202, v202, v143
ds_read_b128 v[180:183], v11 offset:40960
v_mfma_f32_32x32x16_bf16 v[40:55], v[188:191], v[164:167], v[40:55]
buffer_load_dwordx4 v5, s[12:15], s43 offen offset:1024 nt lds
v_max_f32 v203, v203, v151
v_max3_f32 v200, v200, v201, v202
v_max_f32 v200, v200, v203
v_mfma_f32_32x32x16_bf16 v[56:71], v[192:195], v[164:167], v[56:71]
buffer_load_dwordx4 v6, s[12:15], s43 offen offset:2048 nt lds
v_mov_b32 v201, v200
s_nop 1
v_permlane32_swap_b32 v200, v201
v_mfma_f32_32x32x16_bf16 v[72:87], v[196:199], v[164:167], v[72:87]
buffer_load_dwordx4 v7, s[12:15], s43 offen offset:3072 nt lds
s_add_u32 s43, s43, 16384
v_max_f32 v200, v200, v201
v_mul_f32 v204, s46, v200
v_cmp_gt_f32 vcc, v204, v21
s_cbranch_vccz L_nors_1
s_nop 15
v_max_f32 v205, v18, v204
v_sub_f32 v206, v18, v205
v_exp_f32 v20, v206
v_mov_b32 v18, v205
v_add_f32 v21, 0x41000000, v205
v_mul_f32 v19, v20, v19
v_mul_f32 v24, v20, v24
v_mul_f32 v25, v20, v25
v_mul_f32 v26, v20, v26
v_mul_f32 v27, v20, v27
v_mul_f32 v28, v20, v28
v_mul_f32 v29, v20, v29
v_mul_f32 v30, v20, v30
v_mul_f32 v31, v20, v31
v_mul_f32 v32, v20, v32
v_mul_f32 v33, v20, v33
v_mul_f32 v34, v20, v34
v_mul_f32 v35, v20, v35
v_mul_f32 v36, v20, v36
v_mul_f32 v37, v20, v37
v_mul_f32 v38, v20, v38
v_mul_f32 v39, v20, v39
v_mul_f32 v40, v20, v40
v_mul_f32 v41, v20, v41
v_mul_f32 v42, v20, v42
v_mul_f32 v43, v20, v43
v_mul_f32 v44, v20, v44
v_mul_f32 v45, v20, v45
v_mul_f32 v46, v20, v46
v_mul_f32 v47, v20, v47
v_mul_f32 v48, v20, v48
v_mul_f32 v49, v20, v49
v_mul_f32 v50, v20, v50
v_mul_f32 v51, v20, v51
v_mul_f32 v52, v20, v52
v_mul_f32 v53, v20, v53
v_mul_f32 v54, v20, v54
v_mul_f32 v55, v20, v55
v_mul_f32 v56, v20, v56
v_mul_f32 v57, v20, v57
v_mul_f32 v58, v20, v58
v_mul_f32 v59, v20, v59
v_mul_f32 v60, v20, v60
v_mul_f32 v61, v20, v61
v_mul_f32 v62, v20, v62
v_mul_f32 v63, v20, v63
v_mul_f32 v64, v20, v64
v_mul_f32 v65, v20, v65
v_mul_f32 v66, v20, v66
v_mul_f32 v67, v20, v67
v_mul_f32 v68, v20, v68
v_mul_f32 v69, v20, v69
v_mul_f32 v70, v20, v70
v_mul_f32 v71, v20, v71
v_mul_f32 v72, v20, v72
v_mul_f32 v73, v20, v73
v_mul_f32 v74, v20, v74
v_mul_f32 v75, v20, v75
v_mul_f32 v76, v20, v76
v_mul_f32 v77, v20, v77
v_mul_f32 v78, v20, v78
v_mul_f32 v79, v20, v79
v_mul_f32 v80, v20, v80
v_mul_f32 v81, v20, v81
v_mul_f32 v82, v20, v82
v_mul_f32 v83, v20, v83
v_mul_f32 v84, v20, v84
v_mul_f32 v85, v20, v85
v_mul_f32 v86, v20, v86
v_mul_f32 v87, v20, v87
L_nors_1:
ds_read_b128 v[184:187], v12 offset:32768
ds_read_b128 v[188:191], v12 offset:40960
ds_read_b128 v[192:195], v13 offset:32768
s_waitcnt lgkmcnt(6)
v_mfma_f32_32x32x16_bf16 v[88:103], v[168:171], v[224:227], 0
v_fma_f32 v120, v120, s46, -v18
v_fma_f32 v121, v121, s46, -v18
v_fma_f32 v122, v122, s46, -v18
v_fma_f32 v123, v123, s46, -v18
v_fma_f32 v124, v124, s46, -v18
v_fma_f32 v125, v125, s46, -v18
ds_read_b128 v[196:199], v13 offset:40960
s_waitcnt lgkmcnt(6)
v_mfma_f32_32x32x16_bf16 v[104:119], v[172:175], v[224:227], 0
v_fma_f32 v126, v126, s46, -v18
v_fma_f32 v127, v127, s46, -v18
v_exp_f32 v120, v120
v_exp_f32 v121, v121
v_exp_f32 v122, v122
ds_read_b128 v[168:171], v14 offset:32768
s_waitcnt lgkmcnt(6)
v_mfma_f32_32x32x16_bf16 v[88:103], v[176:179], v[228:231], v[88:103]
v_exp_f32 v123, v123
v_fma_f32 v128, v128, s46, -v18
v_fma_f32 v129, v129, s46, -v18
v_fma_f32 v130, v130, s46, -v18
v_fma_f32 v131, v131, s46, -v18
ds_read_b128 v[172:175], v14 offset:40960
s_waitcnt lgkmcnt(6)
v_mfma_f32_32x32x16_bf16 v[104:119], v[180:183], v[228:231], v[104:119]
v_exp_f32 v124, v124
v_exp_f32 v125, v125
v_exp_f32 v126, v126
v_exp_f32 v127, v127
v_add_f32 v208, v120, v121
v_add_f32 v209, v122, v123
ds_read_b128 v[176:179], v15 offset:32768
s_waitcnt lgkmcnt(6)
v_mfma_f32_32x32x16_bf16 v[88:103], v[184:187], v[232:235], v[88:103]
v_cvt_pk_bf16_f32 v152, v120, v121
v_cvt_pk_bf16_f32 v153, v122, v123
v_fma_f32 v132, v132, s46, -v18
v_fma_f32 v133, v133, s46, -v18
v_fma_f32 v134, v134, s46, -v18
ds_read_b128 v[180:183], v15 offset:40960
s_waitcnt lgkmcnt(6)
v_mfma_f32_32x32x16_bf16 v[104:119], v[188:191], v[232:235], v[104:119]
v_fma_f32 v135, v135, s46, -v18
v_exp_f32 v128, v128
v_exp_f32 v129, v129
v_exp_f32 v130, v130
v_exp_f32 v131, v131
ds_read_b128 v[184:187], v16 offset:32768
s_waitcnt lgkmcnt(6)
v_mfma_f32_32x32x16_bf16 v[88:103], v[192:195], v[236:239], v[88:103]
v_add_f32 v208, v208, v124
v_add_f32 v209, v209, v126
v_add_f32 v208, v208, v125
v_add_f32 v209, v209, v127
v_cvt_pk_bf16_f32 v154, v124, v125
v_cvt_pk_bf16_f32 v155, v126, v127
ds_read_b128 v[188:191], v16 offset:40960
s_waitcnt lgkmcnt(6)
v_mfma_f32_32x32x16_bf16 v[104:119], v[196:199], v[236:239], v[104:119]
v_exp_f32 v132, v132
v_exp_f32 v133, v133
v_exp_f32 v134, v134
v_exp_f32 v135, v135
v_add_f32 v208, v208, v128
ds_read_b128 v[192:195], v17 offset:32768
s_waitcnt lgkmcnt(6)
v_mfma_f32_32x32x16_bf16 v[88:103], v[168:171], v[240:243], v[88:103]
v_add_f32 v209, v209, v130
v_add_f32 v208, v208, v129
v_add_f32 v209, v209, v131
v_cvt_pk_bf16_f32 v156, v128, v129
v_cvt_pk_bf16_f32 v157, v130, v131
ds_read_b128 v[196:199], v17 offset:40960
s_waitcnt lgkmcnt(6)
v_mfma_f32_32x32x16_bf16 v[104:119], v[172:175], v[240:243], v[104:119]
v_add_f32 v208, v208, v132
v_add_f32 v209, v209, v134
v_add_f32 v208, v208, v133
v_add_f32 v209, v209, v135
v_cvt_pk_bf16_f32 v158, v132, v133
v_cvt_pk_bf16_f32 v159, v134, v135
s_waitcnt lgkmcnt(5)
v_mfma_f32_32x32x16_bf16 v[88:103], v[176:179], v[244:247], v[88:103]
v_add_f32 v208, v208, v209
v_add_f32 v19, v19, v208
v_fma_f32 v136, v136, s46, -v18
v_fma_f32 v137, v137, s46, -v18
v_fma_f32 v138, v138, s46, -v18
s_waitcnt lgkmcnt(4)
v_mfma_f32_32x32x16_bf16 v[104:119], v[180:183], v[244:247], v[104:119]
v_fma_f32 v139, v139, s46, -v18
v_fma_f32 v140, v140, s46, -v18
v_fma_f32 v141, v141, s46, -v18
v_fma_f32 v142, v142, s46, -v18
v_fma_f32 v143, v143, s46, -v18
s_waitcnt lgkmcnt(0)
s_waitcnt vmcnt(8)
s_barrier
ds_read_b64_tr_b16 v[168:169], v212 offset:49152
ds_read_b64_tr_b16 v[170:171], v213 offset:51200
ds_read_b64_tr_b16 v[172:173], v214 offset:49152
ds_read_b64_tr_b16 v[174:175], v215 offset:51200
ds_read_b64_tr_b16 v[176:177], v216 offset:49152
ds_read_b64_tr_b16 v[178:179], v217 offset:51200
v_mfma_f32_32x32x16_bf16 v[88:103], v[184:187], v[248:251], v[88:103]
s_add_u32 s3, s55, 32768
s_mov_b32 m0, s3
s_nop 0
buffer_load_dwordx4 v4, s[8:11], s42 offen offset:0 nt lds
v_exp_f32 v136, v136
v_exp_f32 v137, v137
v_exp_f32 v138, v138
v_exp_f32 v139, v139
v_fma_f32 v144, v144, s46, -v18
v_fma_f32 v145, v145, s46, -v18
ds_read_b64_tr_b16 v[180:181], v218 offset:49152
ds_read_b64_tr_b16 v[182:183], v219 offset:51200
v_mfma_f32_32x32x16_bf16 v[104:119], v[188:191], v[248:251], v[104:119]
buffer_load_dwordx4 v5, s[8:11], s42 offen offset:1024 nt lds
v_fma_f32 v146, v146, s46, -v18
v_fma_f32 v147, v147, s46, -v18
v_exp_f32 v140, v140
v_exp_f32 v141, v141
v_exp_f32 v142, v142
ds_read_b64_tr_b16 v[184:185], v212 offset:53248
ds_read_b64_tr_b16 v[186:187], v213 offset:55296
v_mfma_f32_32x32x16_bf16 v[88:103], v[192:195], v[252:255], v[88:103]
buffer_load_dwordx4 v6, s[8:11], s42 offen offset:2048 nt lds
v_exp_f32 v143, v143
v_add_f32 v210, v136, v137
v_add_f32 v211, v138, v139
v_cvt_pk_bf16_f32 v160, v136, v137
v_cvt_pk_bf16_f32 v161, v138, v139
ds_read_b64_tr_b16 v[188:189], v214 offset:53248
ds_read_b64_tr_b16 v[190:191], v215 offset:55296
v_mfma_f32_32x32x16_bf16 v[104:119], v[196:199], v[252:255], v[104:119]
buffer_load_dwordx4 v7, s[8:11], s42 offen offset:3072 nt lds
s_add_u32 s42, s42, 16384
ds_read_b64_tr_b16 v[192:193], v216 offset:53248
ds_read_b64_tr_b16 v[194:195], v217 offset:55296
s_waitcnt lgkmcnt(12)
v_mfma_f32_32x32x16_bf16 v[24:39], v[168:171], v[152:155], v[24:39]
v_fma_f32 v148, v148, s46, -v18
v_fma_f32 v149, v149, s46, -v18
v_fma_f32 v150, v150, s46, -v18
v_fma_f32 v151, v151, s46, -v18
v_exp_f32 v144, v144
ds_read_b64_tr_b16 v[196:197], v218 offset:53248
ds_read_b64_tr_b16 v[198:199], v219 offset:55296
s_waitcnt lgkmcnt(12)
v_mfma_f32_32x32x16_bf16 v[40:55], v[172:175], v[152:155], v[40:55]
v_exp_f32 v145, v145
v_exp_f32 v146, v146
v_exp_f32 v147, v147
v_add_f32 v210, v210, v140
v_add_f32 v211, v211, v142
ds_read_b64_tr_b16 v[168:169], v212 offset:57344
ds_read_b64_tr_b16 v[170:171], v213 offset:59392
s_waitcnt lgkmcnt(12)
v_mfma_f32_32x32x16_bf16 v[56:71], v[176:179], v[152:155], v[56:71]
v_add_f32 v210, v210, v141
v_add_f32 v211, v211, v143
v_cvt_pk_bf16_f32 v162, v140, v141
v_cvt_pk_bf16_f32 v163, v142, v143
ds_read_b64_tr_b16 v[172:173], v214 offset:57344
ds_read_b64_tr_b16 v[174:175], v215 offset:59392
s_waitcnt lgkmcnt(12)
v_mfma_f32_32x32x16_bf16 v[72:87], v[180:183], v[152:155], v[72:87]
v_exp_f32 v148, v148
v_exp_f32 v149, v149
v_exp_f32 v150, v150
v_exp_f32 v151, v151
v_add_f32 v210, v210, v144
ds_read_b64_tr_b16 v[176:177], v216 offset:57344
ds_read_b64_tr_b16 v[178:179], v217 offset:59392
s_waitcnt lgkmcnt(12)
v_mfma_f32_32x32x16_bf16 v[24:39], v[184:187], v[156:159], v[24:39]
v_add_f32 v211, v211, v146
v_add_f32 v210, v210, v145
v_add_f32 v211, v211, v147
v_cvt_pk_bf16_f32 v164, v144, v145
ds_read_b64_tr_b16 v[180:181], v218 offset:57344
ds_read_b64_tr_b16 v[182:183], v219 offset:59392
s_waitcnt lgkmcnt(12)
v_mfma_f32_32x32x16_bf16 v[40:55], v[188:191], v[156:159], v[40:55]
v_cvt_pk_bf16_f32 v165, v146, v147
v_add_f32 v210, v210, v148
v_add_f32 v211, v211, v150
v_add_f32 v210, v210, v149
v_add_f32 v211, v211, v151
ds_read_b64_tr_b16 v[184:185], v212 offset:61440
ds_read_b64_tr_b16 v[186:187], v213 offset:63488
s_waitcnt lgkmcnt(12)
v_mfma_f32_32x32x16_bf16 v[56:71], v[192:195], v[156:159], v[56:71]
v_cvt_pk_bf16_f32 v166, v148, v149
v_cvt_pk_bf16_f32 v167, v150, v151
v_add_f32 v210, v210, v211
v_add_f32 v19, v19, v210
ds_read_b64_tr_b16 v[188:189], v214 offset:61440
ds_read_b64_tr_b16 v[190:191], v215 offset:63488
s_waitcnt lgkmcnt(12)
v_mfma_f32_32x32x16_bf16 v[72:87], v[196:199], v[156:159], v[72:87]
ds_read_b64_tr_b16 v[192:193], v216 offset:61440
ds_read_b64_tr_b16 v[194:195], v217 offset:63488
s_waitcnt lgkmcnt(12)
v_mfma_f32_32x32x16_bf16 v[24:39], v[168:171], v[160:163], v[24:39]
v_max3_f32 v200, v88, v89, v90
v_max3_f32 v201, v96, v97, v98
v_max3_f32 v202, v104, v105, v106
ds_read_b64_tr_b16 v[196:197], v218 offset:61440
ds_read_b64_tr_b16 v[198:199], v219 offset:63488
s_waitcnt lgkmcnt(12)
v_mfma_f32_32x32x16_bf16 v[40:55], v[172:175], v[160:163], v[40:55]
v_max3_f32 v203, v112, v113, v114
v_max3_f32 v200, v200, v91, v92
v_max3_f32 v201, v201, v99, v100
s_waitcnt lgkmcnt(10)
v_mfma_f32_32x32x16_bf16 v[56:71], v[176:179], v[160:163], v[56:71]
v_max3_f32 v202, v202, v107, v108
v_max3_f32 v203, v203, v115, v116
v_max3_f32 v200, v200, v93, v94
s_waitcnt lgkmcnt(8)
v_mfma_f32_32x32x16_bf16 v[72:87], v[180:183], v[160:163], v[72:87]
v_max3_f32 v201, v201, v101, v102
v_max3_f32 v202, v202, v109, v110
v_max3_f32 v203, v203, v117, v118
s_waitcnt lgkmcnt(0)
s_waitcnt vmcnt(8)
s_barrier
ds_read_b128 v[168:171], v10 offset:0
ds_read_b128 v[172:175], v10 offset:8192
ds_read_b128 v[176:179], v11 offset:0
v_mfma_f32_32x32x16_bf16 v[24:39], v[184:187], v[164:167], v[24:39]
s_add_u32 s3, s55, 49152
s_mov_b32 m0, s3
s_nop 0
buffer_load_dwordx4 v4, s[12:15], s43 offen offset:0 nt lds
v_max_f32 v200, v200, v95
v_max_f32 v201, v201, v103
v_max_f32 v202, v202, v111
ds_read_b128 v[180:183], v11 offset:8192
v_mfma_f32_32x32x16_bf16 v[40:55], v[188:191], v[164:167], v[40:55]
buffer_load_dwordx4 v5, s[12:15], s43 offen offset:1024 nt lds
v_max_f32 v203, v203, v119
v_max3_f32 v200, v200, v201, v202
v_max_f32 v200, v200, v203
v_mfma_f32_32x32x16_bf16 v[56:71], v[192:195], v[164:167], v[56:71]
buffer_load_dwordx4 v6, s[12:15], s43 offen offset:2048 nt lds
v_mov_b32 v201, v200
s_nop 1
v_permlane32_swap_b32 v200, v201
v_mfma_f32_32x32x16_bf16 v[72:87], v[196:199], v[164:167], v[72:87]
buffer_load_dwordx4 v7, s[12:15], s43 offen offset:3072 nt lds
s_add_u32 s43, s43, 16384
v_max_f32 v200, v200, v201
v_mul_f32 v204, s46, v200
v_cmp_gt_f32 vcc, v204, v21
s_add_u32 s45, s45, 1
s_cmp_lt_u32 s45, 7
s_cbranch_scc1 L_loop
s_cbranch_vccz L_nors_2
s_nop 15
v_max_f32 v205, v18, v204
v_sub_f32 v206, v18, v205
v_exp_f32 v20, v206
v_mov_b32 v18, v205
v_add_f32 v21, 0x41000000, v205
v_mul_f32 v19, v20, v19
v_mul_f32 v24, v20, v24
v_mul_f32 v25, v20, v25
v_mul_f32 v26, v20, v26
v_mul_f32 v27, v20, v27
v_mul_f32 v28, v20, v28
v_mul_f32 v29, v20, v29
v_mul_f32 v30, v20, v30
v_mul_f32 v31, v20, v31
v_mul_f32 v32, v20, v32
v_mul_f32 v33, v20, v33
v_mul_f32 v34, v20, v34
v_mul_f32 v35, v20, v35
v_mul_f32 v36, v20, v36
v_mul_f32 v37, v20, v37
v_mul_f32 v38, v20, v38
v_mul_f32 v39, v20, v39
v_mul_f32 v40, v20, v40
v_mul_f32 v41, v20, v41
v_mul_f32 v42, v20, v42
v_mul_f32 v43, v20, v43
v_mul_f32 v44, v20, v44
v_mul_f32 v45, v20, v45
v_mul_f32 v46, v20, v46
v_mul_f32 v47, v20, v47
v_mul_f32 v48, v20, v48
v_mul_f32 v49, v20, v49
v_mul_f32 v50, v20, v50
v_mul_f32 v51, v20, v51
v_mul_f32 v52, v20, v52
v_mul_f32 v53, v20, v53
v_mul_f32 v54, v20, v54
v_mul_f32 v55, v20, v55
v_mul_f32 v56, v20, v56
v_mul_f32 v57, v20, v57
v_mul_f32 v58, v20, v58
v_mul_f32 v59, v20, v59
v_mul_f32 v60, v20, v60
v_mul_f32 v61, v20, v61
v_mul_f32 v62, v20, v62
v_mul_f32 v63, v20, v63
v_mul_f32 v64, v20, v64
v_mul_f32 v65, v20, v65
v_mul_f32 v66, v20, v66
v_mul_f32 v67, v20, v67
v_mul_f32 v68, v20, v68
v_mul_f32 v69, v20, v69
v_mul_f32 v70, v20, v70
v_mul_f32 v71, v20, v71
v_mul_f32 v72, v20, v72
v_mul_f32 v73, v20, v73
v_mul_f32 v74, v20, v74
v_mul_f32 v75, v20, v75
v_mul_f32 v76, v20, v76
v_mul_f32 v77, v20, v77
v_mul_f32 v78, v20, v78
v_mul_f32 v79, v20, v79
v_mul_f32 v80, v20, v80
v_mul_f32 v81, v20, v81
v_mul_f32 v82, v20, v82
v_mul_f32 v83, v20, v83
v_mul_f32 v84, v20, v84
v_mul_f32 v85, v20, v85
v_mul_f32 v86, v20, v86
v_mul_f32 v87, v20, v87
L_nors_2:
ds_read_b128 v[184:187], v12 offset:0
ds_read_b128 v[188:191], v12 offset:8192
ds_read_b128 v[192:195], v13 offset:0
s_waitcnt lgkmcnt(6)
v_mfma_f32_32x32x16_bf16 v[120:135], v[168:171], v[224:227], 0
v_fma_f32 v88, v88, s46, -v18
v_fma_f32 v89, v89, s46, -v18
v_fma_f32 v90, v90, s46, -v18
v_fma_f32 v91, v91, s46, -v18
v_fma_f32 v92, v92, s46, -v18
v_fma_f32 v93, v93, s46, -v18
ds_read_b128 v[196:199], v13 offset:8192
s_waitcnt lgkmcnt(6)
v_mfma_f32_32x32x16_bf16 v[136:151], v[172:175], v[224:227], 0
v_fma_f32 v94, v94, s46, -v18
v_fma_f32 v95, v95, s46, -v18
v_exp_f32 v88, v88
v_exp_f32 v89, v89
v_exp_f32 v90, v90
ds_read_b128 v[168:171], v14 offset:0
s_waitcnt lgkmcnt(6)
v_mfma_f32_32x32x16_bf16 v[120:135], v[176:179], v[228:231], v[120:135]
v_exp_f32 v91, v91
v_fma_f32 v96, v96, s46, -v18
v_fma_f32 v97, v97, s46, -v18
v_fma_f32 v98, v98, s46, -v18
v_fma_f32 v99, v99, s46, -v18
ds_read_b128 v[172:175], v14 offset:8192
s_waitcnt lgkmcnt(6)
v_mfma_f32_32x32x16_bf16 v[136:151], v[180:183], v[228:231], v[136:151]
v_exp_f32 v92, v92
v_exp_f32 v93, v93
v_exp_f32 v94, v94
v_exp_f32 v95, v95
v_add_f32 v208, v88, v89
v_add_f32 v209, v90, v91
ds_read_b128 v[176:179], v15 offset:0
s_waitcnt lgkmcnt(6)
v_mfma_f32_32x32x16_bf16 v[120:135], v[184:187], v[232:235], v[120:135]
v_cvt_pk_bf16_f32 v152, v88, v89
v_cvt_pk_bf16_f32 v153, v90, v91
v_fma_f32 v100, v100, s46, -v18
v_fma_f32 v101, v101, s46, -v18
v_fma_f32 v102, v102, s46, -v18
ds_read_b128 v[180:183], v15 offset:8192
s_waitcnt lgkmcnt(6)
v_mfma_f32_32x32x16_bf16 v[136:151], v[188:191], v[232:235], v[136:151]
v_fma_f32 v103, v103, s46, -v18
v_exp_f32 v96, v96
v_exp_f32 v97, v97
v_exp_f32 v98, v98
v_exp_f32 v99, v99
ds_read_b128 v[184:187], v16 offset:0
s_waitcnt lgkmcnt(6)
v_mfma_f32_32x32x16_bf16 v[120:135], v[192:195], v[236:239], v[120:135]
v_add_f32 v208, v208, v92
v_add_f32 v209, v209, v94
v_add_f32 v208, v208, v93
v_add_f32 v209, v209, v95
v_cvt_pk_bf16_f32 v154, v92, v93
v_cvt_pk_bf16_f32 v155, v94, v95
ds_read_b128 v[188:191], v16 offset:8192
s_waitcnt lgkmcnt(6)
v_mfma_f32_32x32x16_bf16 v[136:151], v[196:199], v[236:239], v[136:151]
v_exp_f32 v100, v100
v_exp_f32 v101, v101
v_exp_f32 v102, v102
v_exp_f32 v103, v103
v_add_f32 v208, v208, v96
ds_read_b128 v[192:195], v17 offset:0
s_waitcnt lgkmcnt(6)
v_mfma_f32_32x32x16_bf16 v[120:135], v[168:171], v[240:243], v[120:135]
v_add_f32 v209, v209, v98
v_add_f32 v208, v208, v97
v_add_f32 v209, v209, v99
v_cvt_pk_bf16_f32 v156, v96, v97
v_cvt_pk_bf16_f32 v157, v98, v99
ds_read_b128 v[196:199], v17 offset:8192
s_waitcnt lgkmcnt(6)
v_mfma_f32_32x32x16_bf16 v[136:151], v[172:175], v[240:243], v[136:151]
v_add_f32 v208, v208, v100
v_add_f32 v209, v209, v102
v_add_f32 v208, v208, v101
v_add_f32 v209, v209, v103
v_cvt_pk_bf16_f32 v158, v100, v101
v_cvt_pk_bf16_f32 v159, v102, v103
s_waitcnt lgkmcnt(5)
v_mfma_f32_32x32x16_bf16 v[120:135], v[176:179], v[244:247], v[120:135]
v_add_f32 v208, v208, v209
v_add_f32 v19, v19, v208
v_fma_f32 v104, v104, s46, -v18
v_fma_f32 v105, v105, s46, -v18
v_fma_f32 v106, v106, s46, -v18
s_waitcnt lgkmcnt(4)
v_mfma_f32_32x32x16_bf16 v[136:151], v[180:183], v[244:247], v[136:151]
v_fma_f32 v107, v107, s46, -v18
v_fma_f32 v108, v108, s46, -v18
v_fma_f32 v109, v109, s46, -v18
v_fma_f32 v110, v110, s46, -v18
v_fma_f32 v111, v111, s46, -v18
s_waitcnt lgkmcnt(0)
s_waitcnt vmcnt(8)
s_barrier
ds_read_b64_tr_b16 v[168:169], v212 offset:16384
ds_read_b64_tr_b16 v[170:171], v213 offset:18432
ds_read_b64_tr_b16 v[172:173], v214 offset:16384
ds_read_b64_tr_b16 v[174:175], v215 offset:18432
ds_read_b64_tr_b16 v[176:177], v216 offset:16384
ds_read_b64_tr_b16 v[178:179], v217 offset:18432
v_mfma_f32_32x32x16_bf16 v[120:135], v[184:187], v[248:251], v[120:135]
s_add_u32 s3, s55, 0
s_mov_b32 m0, s3
s_add_u32 s50, s60, 0
buffer_load_dwordx4 v222, s[56:59], s50 offen lds
v_exp_f32 v104, v104
v_exp_f32 v105, v105
v_exp_f32 v106, v106
v_exp_f32 v107, v107
v_fma_f32 v112, v112, s46, -v18
v_fma_f32 v113, v113, s46, -v18
ds_read_b64_tr_b16 v[180:181], v218 offset:16384
ds_read_b64_tr_b16 v[182:183], v219 offset:18432
v_mfma_f32_32x32x16_bf16 v[136:151], v[188:191], v[248:251], v[136:151]
s_add_u32 s3, s55, 1024
s_mov_b32 m0, s3
s_add_u32 s50, s60, 9216
buffer_load_dwordx4 v222, s[56:59], s50 offen lds
v_fma_f32 v114, v114, s46, -v18
v_fma_f32 v115, v115, s46, -v18
v_exp_f32 v108, v108
v_exp_f32 v109, v109
v_exp_f32 v110, v110
ds_read_b64_tr_b16 v[184:185], v212 offset:20480
ds_read_b64_tr_b16 v[186:187], v213 offset:22528
v_mfma_f32_32x32x16_bf16 v[120:135], v[192:195], v[252:255], v[120:135]
s_add_u32 s3, s55, 2048
s_mov_b32 m0, s3
s_add_u32 s50, s60, 18432
buffer_load_dwordx4 v222, s[56:59], s50 offen lds
v_exp_f32 v111, v111
v_add_f32 v210, v104, v105
v_add_f32 v211, v106, v107
v_cvt_pk_bf16_f32 v160, v104, v105
v_cvt_pk_bf16_f32 v161, v106, v107
ds_read_b64_tr_b16 v[188:189], v214 offset:20480
ds_read_b64_tr_b16 v[190:191], v215 offset:22528
v_mfma_f32_32x32x16_bf16 v[136:151], v[196:199], v[252:255], v[136:151]
s_add_u32 s3, s55, 3072
s_mov_b32 m0, s3
s_add_u32 s50, s60, 27648
buffer_load_dwordx4 v222, s[56:59], s50 offen lds
ds_read_b64_tr_b16 v[192:193], v216 offset:20480
ds_read_b64_tr_b16 v[194:195], v217 offset:22528
s_waitcnt lgkmcnt(12)
v_mfma_f32_32x32x16_bf16 v[24:39], v[168:171], v[152:155], v[24:39]
v_fma_f32 v116, v116, s46, -v18
v_fma_f32 v117, v117, s46, -v18
v_fma_f32 v118, v118, s46, -v18
v_fma_f32 v119, v119, s46, -v18
v_exp_f32 v112, v112
ds_read_b64_tr_b16 v[196:197], v218 offset:20480
ds_read_b64_tr_b16 v[198:199], v219 offset:22528
s_waitcnt lgkmcnt(12)
v_mfma_f32_32x32x16_bf16 v[40:55], v[172:175], v[152:155], v[40:55]
v_exp_f32 v113, v113
v_exp_f32 v114, v114
v_exp_f32 v115, v115
v_add_f32 v210, v210, v108
v_add_f32 v211, v211, v110
ds_read_b64_tr_b16 v[168:169], v212 offset:24576
ds_read_b64_tr_b16 v[170:171], v213 offset:26624
s_waitcnt lgkmcnt(12)
v_mfma_f32_32x32x16_bf16 v[56:71], v[176:179], v[152:155], v[56:71]
v_add_f32 v210, v210, v109
v_add_f32 v211, v211, v111
v_cvt_pk_bf16_f32 v162, v108, v109
v_cvt_pk_bf16_f32 v163, v110, v111
ds_read_b64_tr_b16 v[172:173], v214 offset:24576
ds_read_b64_tr_b16 v[174:175], v215 offset:26624
s_waitcnt lgkmcnt(12)
v_mfma_f32_32x32x16_bf16 v[72:87], v[180:183], v[152:155], v[72:87]
v_exp_f32 v116, v116
v_exp_f32 v117, v117
v_exp_f32 v118, v118
v_exp_f32 v119, v119
v_add_f32 v210, v210, v112
ds_read_b64_tr_b16 v[176:177], v216 offset:24576
ds_read_b64_tr_b16 v[178:179], v217 offset:26624
s_waitcnt lgkmcnt(12)
v_mfma_f32_32x32x16_bf16 v[24:39], v[184:187], v[156:159], v[24:39]
v_add_f32 v211, v211, v114
v_add_f32 v210, v210, v113
v_add_f32 v211, v211, v115
v_cvt_pk_bf16_f32 v164, v112, v113
ds_read_b64_tr_b16 v[180:181], v218 offset:24576
ds_read_b64_tr_b16 v[182:183], v219 offset:26624
s_waitcnt lgkmcnt(12)
v_mfma_f32_32x32x16_bf16 v[40:55], v[188:191], v[156:159], v[40:55]
v_cvt_pk_bf16_f32 v165, v114, v115
v_add_f32 v210, v210, v116
v_add_f32 v211, v211, v118
v_add_f32 v210, v210, v117
v_add_f32 v211, v211, v119
ds_read_b64_tr_b16 v[184:185], v212 offset:28672
ds_read_b64_tr_b16 v[186:187], v213 offset:30720
s_waitcnt lgkmcnt(12)
v_mfma_f32_32x32x16_bf16 v[56:71], v[192:195], v[156:159], v[56:71]
v_cvt_pk_bf16_f32 v166, v116, v117
v_cvt_pk_bf16_f32 v167, v118, v119
v_add_f32 v210, v210, v211
v_add_f32 v19, v19, v210
ds_read_b64_tr_b16 v[188:189], v214 offset:28672
ds_read_b64_tr_b16 v[190:191], v215 offset:30720
s_waitcnt lgkmcnt(12)
v_mfma_f32_32x32x16_bf16 v[72:87], v[196:199], v[156:159], v[72:87]
ds_read_b64_tr_b16 v[192:193], v216 offset:28672
ds_read_b64_tr_b16 v[194:195], v217 offset:30720
s_waitcnt lgkmcnt(12)
v_mfma_f32_32x32x16_bf16 v[24:39], v[168:171], v[160:163], v[24:39]
v_max3_f32 v200, v120, v121, v122
v_max3_f32 v201, v128, v129, v130
v_max3_f32 v202, v136, v137, v138
ds_read_b64_tr_b16 v[196:197], v218 offset:28672
ds_read_b64_tr_b16 v[198:199], v219 offset:30720
s_waitcnt lgkmcnt(12)
v_mfma_f32_32x32x16_bf16 v[40:55], v[172:175], v[160:163], v[40:55]
v_max3_f32 v203, v144, v145, v146
v_max3_f32 v200, v200, v123, v124
v_max3_f32 v201, v201, v131, v132
s_waitcnt lgkmcnt(10)
v_mfma_f32_32x32x16_bf16 v[56:71], v[176:179], v[160:163], v[56:71]
v_max3_f32 v202, v202, v139, v140
v_max3_f32 v203, v203, v147, v148
v_max3_f32 v200, v200, v125, v126
s_waitcnt lgkmcnt(8)
v_mfma_f32_32x32x16_bf16 v[72:87], v[180:183], v[160:163], v[72:87]
v_max3_f32 v201, v201, v133, v134
v_max3_f32 v202, v202, v141, v142
v_max3_f32 v203, v203, v149, v150
s_waitcnt lgkmcnt(0)
s_waitcnt vmcnt(8)
s_barrier
v_mfma_f32_32x32x16_bf16 v[24:39], v[184:187], v[164:167], v[24:39]
s_add_u32 s3, s55, 16384
s_mov_b32 m0, s3
s_add_u32 s50, s60, 147456
buffer_load_dwordx4 v222, s[56:59], s50 offen lds
v_max_f32 v200, v200, v127
v_max_f32 v201, v201, v135
v_max_f32 v202, v202, v143
v_mfma_f32_32x32x16_bf16 v[40:55], v[188:191], v[164:167], v[40:55]
s_add_u32 s3, s55, 17408
s_mov_b32 m0, s3
s_add_u32 s50, s60, 156672
buffer_load_dwordx4 v222, s[56:59], s50 offen lds
v_max_f32 v203, v203, v151
v_max3_f32 v200, v200, v201, v202
v_max_f32 v200, v200, v203
v_mfma_f32_32x32x16_bf16 v[56:71], v[192:195], v[164:167], v[56:71]
s_add_u32 s3, s55, 18432
s_mov_b32 m0, s3
s_add_u32 s50, s60, 165888
buffer_load_dwordx4 v222, s[56:59], s50 offen lds
v_mov_b32 v201, v200
s_nop 1
v_permlane32_swap_b32 v200, v201
v_mfma_f32_32x32x16_bf16 v[72:87], v[196:199], v[164:167], v[72:87]
s_add_u32 s3, s55, 19456
s_mov_b32 m0, s3
s_add_u32 s50, s60, 175104
buffer_load_dwordx4 v222, s[56:59], s50 offen lds
v_max_f32 v200, v200, v201
v_mul_f32 v204, s46, v200
v_cmp_gt_f32 vcc, v204, v21
s_cmp_ge_u32 s51, 5
s_cbranch_scc1 L_nowarm2
s_mul_i32 s3, s63, 1179648
buffer_load_dword v220, v220, s[56:59], s3 offen
L_nowarm2:
s_cbranch_vccz L_nors_3
s_nop 15
v_max_f32 v205, v18, v204
v_sub_f32 v206, v18, v205
v_exp_f32 v20, v206
v_mov_b32 v18, v205
v_add_f32 v21, 0x41000000, v205
v_mul_f32 v19, v20, v19
v_mul_f32 v24, v20, v24
v_mul_f32 v25, v20, v25
v_mul_f32 v26, v20, v26
v_mul_f32 v27, v20, v27
v_mul_f32 v28, v20, v28
v_mul_f32 v29, v20, v29
v_mul_f32 v30, v20, v30
v_mul_f32 v31, v20, v31
v_mul_f32 v32, v20, v32
v_mul_f32 v33, v20, v33
v_mul_f32 v34, v20, v34
v_mul_f32 v35, v20, v35
v_mul_f32 v36, v20, v36
v_mul_f32 v37, v20, v37
v_mul_f32 v38, v20, v38
v_mul_f32 v39, v20, v39
v_mul_f32 v40, v20, v40
v_mul_f32 v41, v20, v41
v_mul_f32 v42, v20, v42
v_mul_f32 v43, v20, v43
v_mul_f32 v44, v20, v44
v_mul_f32 v45, v20, v45
v_mul_f32 v46, v20, v46
v_mul_f32 v47, v20, v47
v_mul_f32 v48, v20, v48
v_mul_f32 v49, v20, v49
v_mul_f32 v50, v20, v50
v_mul_f32 v51, v20, v51
v_mul_f32 v52, v20, v52
v_mul_f32 v53, v20, v53
v_mul_f32 v54, v20, v54
v_mul_f32 v55, v20, v55
v_mul_f32 v56, v20, v56
v_mul_f32 v57, v20, v57
v_mul_f32 v58, v20, v58
v_mul_f32 v59, v20, v59
v_mul_f32 v60, v20, v60
v_mul_f32 v61, v20, v61
v_mul_f32 v62, v20, v62
v_mul_f32 v63, v20, v63
v_mul_f32 v64, v20, v64
v_mul_f32 v65, v20, v65
v_mul_f32 v66, v20, v66
v_mul_f32 v67, v20, v67
v_mul_f32 v68, v20, v68
v_mul_f32 v69, v20, v69
v_mul_f32 v70, v20, v70
v_mul_f32 v71, v20, v71
v_mul_f32 v72, v20, v72
v_mul_f32 v73, v20, v73
v_mul_f32 v74, v20, v74
v_mul_f32 v75, v20, v75
v_mul_f32 v76, v20, v76
v_mul_f32 v77, v20, v77
v_mul_f32 v78, v20, v78
v_mul_f32 v79, v20, v79
v_mul_f32 v80, v20, v80
v_mul_f32 v81, v20, v81
v_mul_f32 v82, v20, v82
v_mul_f32 v83, v20, v83
v_mul_f32 v84, v20, v84
v_mul_f32 v85, v20, v85
v_mul_f32 v86, v20, v86
v_mul_f32 v87, v20, v87
L_nors_3:
s_waitcnt vmcnt(8)
s_barrier
v_fma_f32 v120, v120, s46, -v18
v_fma_f32 v121, v121, s46, -v18
v_fma_f32 v122, v122, s46, -v18
v_fma_f32 v123, v123, s46, -v18
v_fma_f32 v124, v124, s46, -v18
v_fma_f32 v125, v125, s46, -v18
v_fma_f32 v126, v126, s46, -v18
v_fma_f32 v127, v127, s46, -v18
v_exp_f32 v120, v120
v_exp_f32 v121, v121
v_exp_f32 v122, v122
v_exp_f32 v123, v123
v_fma_f32 v128, v128, s46, -v18
v_fma_f32 v129, v129, s46, -v18
v_fma_f32 v130, v130, s46, -v18
v_fma_f32 v131, v131, s46, -v18
v_exp_f32 v124, v124
v_exp_f32 v125, v125
v_exp_f32 v126, v126
v_exp_f32 v127, v127
v_add_f32 v208, v120, v121
v_add_f32 v209, v122, v123
v_cvt_pk_bf16_f32 v152, v120, v121
v_cvt_pk_bf16_f32 v153, v122, v123
v_fma_f32 v132, v132, s46, -v18
v_fma_f32 v133, v133, s46, -v18
v_fma_f32 v134, v134, s46, -v18
v_fma_f32 v135, v135, s46, -v18
v_exp_f32 v128, v128
v_exp_f32 v129, v129
v_exp_f32 v130, v130
v_exp_f32 v131, v131
v_add_f32 v208, v208, v124
v_add_f32 v209, v209, v126
v_add_f32 v208, v208, v125
v_add_f32 v209, v209, v127
v_cvt_pk_bf16_f32 v154, v124, v125
v_cvt_pk_bf16_f32 v155, v126, v127
v_exp_f32 v132, v132
v_exp_f32 v133, v133
v_exp_f32 v134, v134
v_exp_f32 v135, v135
v_add_f32 v208, v208, v128
v_add_f32 v209, v209, v130
v_add_f32 v208, v208, v129
v_add_f32 v209, v209, v131
v_cvt_pk_bf16_f32 v156, v128, v129
v_cvt_pk_bf16_f32 v157, v130, v131
v_add_f32 v208, v208, v132
v_add_f32 v209, v209, v134
v_add_f32 v208, v208, v133
v_add_f32 v209, v209, v135
v_cvt_pk_bf16_f32 v158, v132, v133
v_cvt_pk_bf16_f32 v159, v134, v135
v_add_f32 v208, v208, v209
v_add_f32 v19, v19, v208
v_fma_f32 v136, v136, s46, -v18
v_fma_f32 v137, v137, s46, -v18
v_fma_f32 v138, v138, s46, -v18
v_fma_f32 v139, v139, s46, -v18
v_fma_f32 v140, v140, s46, -v18
v_fma_f32 v141, v141, s46, -v18
v_fma_f32 v142, v142, s46, -v18
v_fma_f32 v143, v143, s46, -v18
v_exp_f32 v136, v136
v_exp_f32 v137, v137
v_exp_f32 v138, v138
v_exp_f32 v139, v139
v_fma_f32 v144, v144, s46, -v18
v_fma_f32 v145, v145, s46, -v18
v_fma_f32 v146, v146, s46, -v18
v_fma_f32 v147, v147, s46, -v18
v_exp_f32 v140, v140
v_exp_f32 v141, v141
v_exp_f32 v142, v142
v_exp_f32 v143, v143
v_add_f32 v210, v136, v137
v_add_f32 v211, v138, v139
v_cvt_pk_bf16_f32 v160, v136, v137
v_cvt_pk_bf16_f32 v161, v138, v139
ds_read_b64_tr_b16 v[168:169], v212 offset:49152
ds_read_b64_tr_b16 v[170:171], v213 offset:51200
ds_read_b64_tr_b16 v[172:173], v214 offset:49152
ds_read_b64_tr_b16 v[174:175], v215 offset:51200
ds_read_b64_tr_b16 v[176:177], v216 offset:49152
ds_read_b64_tr_b16 v[178:179], v217 offset:51200
ds_read_b64_tr_b16 v[180:181], v218 offset:49152
ds_read_b64_tr_b16 v[182:183], v219 offset:51200
ds_read_b64_tr_b16 v[184:185], v212 offset:53248
ds_read_b64_tr_b16 v[186:187], v213 offset:55296
ds_read_b64_tr_b16 v[188:189], v214 offset:53248
ds_read_b64_tr_b16 v[190:191], v215 offset:55296
ds_read_b64_tr_b16 v[192:193], v216 offset:53248
ds_read_b64_tr_b16 v[194:195], v217 offset:55296
s_waitcnt lgkmcnt(12)
v_mfma_f32_32x32x16_bf16 v[24:39], v[168:171], v[152:155], v[24:39]
s_add_u32 s3, s55, 32768
s_mov_b32 m0, s3
s_add_u32 s50, s60, 128
buffer_load_dwordx4 v222, s[56:59], s50 offen lds
v_fma_f32 v148, v148, s46, -v18
v_fma_f32 v149, v149, s46, -v18
v_fma_f32 v150, v150, s46, -v18
v_fma_f32 v151, v151, s46, -v18
v_exp_f32 v144, v144
ds_read_b64_tr_b16 v[196:197], v218 offset:53248
ds_read_b64_tr_b16 v[198:199], v219 offset:55296
s_waitcnt lgkmcnt(12)
v_mfma_f32_32x32x16_bf16 v[40:55], v[172:175], v[152:155], v[40:55]
s_add_u32 s3, s55, 33792
s_mov_b32 m0, s3
s_add_u32 s50, s60, 9344
buffer_load_dwordx4 v222, s[56:59], s50 offen lds
v_exp_f32 v145, v145
v_exp_f32 v146, v146
v_exp_f32 v147, v147
v_add_f32 v210, v210, v140
v_add_f32 v211, v211, v142
ds_read_b64_tr_b16 v[168:169], v212 offset:57344
ds_read_b64_tr_b16 v[170:171], v213 offset:59392
s_waitcnt lgkmcnt(12)
v_mfma_f32_32x32x16_bf16 v[56:71], v[176:179], v[152:155], v[56:71]
s_add_u32 s3, s55, 34816
s_mov_b32 m0, s3
s_add_u32 s50, s60, 18560
buffer_load_dwordx4 v222, s[56:59], s50 offen lds
v_add_f32 v210, v210, v141
v_add_f32 v211, v211, v143
v_cvt_pk_bf16_f32 v162, v140, v141
v_cvt_pk_bf16_f32 v163, v142, v143
ds_read_b64_tr_b16 v[172:173], v214 offset:57344
ds_read_b64_tr_b16 v[174:175], v215 offset:59392
s_waitcnt lgkmcnt(12)
v_mfma_f32_32x32x16_bf16 v[72:87], v[180:183], v[152:155], v[72:87]
s_add_u32 s3, s55, 35840
s_mov_b32 m0, s3
s_add_u32 s50, s60, 27776
buffer_load_dwordx4 v222, s[56:59], s50 offen lds
v_exp_f32 v148, v148
v_exp_f32 v149, v149
v_exp_f32 v150, v150
v_exp_f32 v151, v151
v_add_f32 v210, v210, v144
ds_read_b64_tr_b16 v[176:177], v216 offset:57344
ds_read_b64_tr_b16 v[178:179], v217 offset:59392
s_waitcnt lgkmcnt(12)
v_mfma_f32_32x32x16_bf16 v[24:39], v[184:187], v[156:159], v[24:39]
v_add_f32 v211, v211, v146
v_add_f32 v210, v210, v145
v_add_f32 v211, v211, v147
v_cvt_pk_bf16_f32 v164, v144, v145
ds_read_b64_tr_b16 v[180:181], v218 offset:57344
ds_read_b64_tr_b16 v[182:183], v219 offset:59392
s_waitcnt lgkmcnt(12)
v_mfma_f32_32x32x16_bf16 v[40:55], v[188:191], v[156:159], v[40:55]
v_cvt_pk_bf16_f32 v165, v146, v147
v_add_f32 v210, v210, v148
v_add_f32 v211, v211, v150
v_add_f32 v210, v210, v149
v_add_f32 v211, v211, v151
ds_read_b64_tr_b16 v[184:185], v212 offset:61440
ds_read_b64_tr_b16 v[186:187], v213 offset:63488
s_waitcnt lgkmcnt(12)
v_mfma_f32_32x32x16_bf16 v[56:71], v[192:195], v[156:159], v[56:71]
v_cvt_pk_bf16_f32 v166, v148, v149
v_cvt_pk_bf16_f32 v167, v150, v151
v_add_f32 v210, v210, v211
v_add_f32 v19, v19, v210
ds_read_b64_tr_b16 v[188:189], v214 offset:61440
ds_read_b64_tr_b16 v[190:191], v215 offset:63488
s_waitcnt lgkmcnt(12)
v_mfma_f32_32x32x16_bf16 v[72:87], v[196:199], v[156:159], v[72:87]
ds_read_b64_tr_b16 v[192:193], v216 offset:61440
ds_read_b64_tr_b16 v[194:195], v217 offset:63488
s_waitcnt lgkmcnt(12)
v_mfma_f32_32x32x16_bf16 v[24:39], v[168:171], v[160:163], v[24:39]
ds_read_b64_tr_b16 v[196:197], v218 offset:61440
ds_read_b64_tr_b16 v[198:199], v219 offset:63488
s_waitcnt lgkmcnt(12)
v_mfma_f32_32x32x16_bf16 v[40:55], v[172:175], v[160:163], v[40:55]
s_waitcnt lgkmcnt(10)
v_mfma_f32_32x32x16_bf16 v[56:71], v[176:179], v[160:163], v[56:71]
s_waitcnt lgkmcnt(8)
v_mfma_f32_32x32x16_bf16 v[72:87], v[180:183], v[160:163], v[72:87]
s_waitcnt lgkmcnt(6)
v_mfma_f32_32x32x16_bf16 v[24:39], v[184:187], v[164:167], v[24:39]
s_waitcnt lgkmcnt(4)
v_mfma_f32_32x32x16_bf16 v[40:55], v[188:191], v[164:167], v[40:55]
s_waitcnt lgkmcnt(2)
v_mfma_f32_32x32x16_bf16 v[56:71], v[192:195], v[164:167], v[56:71]
s_waitcnt lgkmcnt(0)
v_mfma_f32_32x32x16_bf16 v[72:87], v[196:199], v[164:167], v[72:87]
v_mov_b32 v201, v19
s_nop 1
v_permlane32_swap_b32 v19, v201
v_add_f32 v19, v19, v201
v_rcp_f32 v20, v19
v_lshlrev_b32 v1, 4, v0
s_lshl_b32 s3, s51, 12
s_add_u32 s3, s3, 131072
v_add_u32 v2, s3, v1
s_add_u32 s3, s55, 49152
v_add_u32 v3, s3, v1
s_nop 7
v_mul_f32 v24, v20, v24
v_mul_f32 v25, v20, v25
v_mul_f32 v26, v20, v26
v_mul_f32 v27, v20, v27
v_mul_f32 v28, v20, v28
v_mul_f32 v29, v20, v29
v_mul_f32 v30, v20, v30
v_mul_f32 v31, v20, v31
v_mul_f32 v32, v20, v32
v_mul_f32 v33, v20, v33
v_mul_f32 v34, v20, v34
v_mul_f32 v35, v20, v35
v_mul_f32 v36, v20, v36
v_mul_f32 v37, v20, v37
v_mul_f32 v38, v20, v38
v_mul_f32 v39, v20, v39
v_mul_f32 v40, v20, v40
v_mul_f32 v41, v20, v41
v_mul_f32 v42, v20, v42
v_mul_f32 v43, v20, v43
v_mul_f32 v44, v20, v44
v_mul_f32 v45, v20, v45
v_mul_f32 v46, v20, v46
v_mul_f32 v47, v20, v47
v_mul_f32 v48, v20, v48
v_mul_f32 v49, v20, v49
v_mul_f32 v50, v20, v50
v_mul_f32 v51, v20, v51
v_mul_f32 v52, v20, v52
v_mul_f32 v53, v20, v53
v_mul_f32 v54, v20, v54
v_mul_f32 v55, v20, v55
v_mul_f32 v56, v20, v56
v_mul_f32 v57, v20, v57
v_mul_f32 v58, v20, v58
v_mul_f32 v59, v20, v59
v_mul_f32 v60, v20, v60
v_mul_f32 v61, v20, v61
v_mul_f32 v62, v20, v62
v_mul_f32 v63, v20, v63
v_mul_f32 v64, v20, v64
v_mul_f32 v65, v20, v65
v_mul_f32 v66, v20, v66
v_mul_f32 v67, v20, v67
v_mul_f32 v68, v20, v68
v_mul_f32 v69, v20, v69
v_mul_f32 v70, v20, v70
v_mul_f32 v71, v20, v71
v_mul_f32 v72, v20, v72
v_mul_f32 v73, v20, v73
v_mul_f32 v74, v20, v74
v_mul_f32 v75, v20, v75
v_mul_f32 v76, v20, v76
v_mul_f32 v77, v20, v77
v_mul_f32 v78, v20, v78
v_mul_f32 v79, v20, v79
v_mul_f32 v80, v20, v80
v_mul_f32 v81, v20, v81
v_mul_f32 v82, v20, v82
v_mul_f32 v83, v20, v83
v_mul_f32 v84, v20, v84
v_mul_f32 v85, v20, v85
v_mul_f32 v86, v20, v86
v_mul_f32 v87, v20, v87
v_cvt_pk_bf16_f32 v88, v24, v25
v_cvt_pk_bf16_f32 v89, v26, v27
v_cvt_pk_bf16_f32 v90, v28, v29
v_cvt_pk_bf16_f32 v91, v30, v31
v_cvt_pk_bf16_f32 v92, v32, v33
v_cvt_pk_bf16_f32 v93, v34, v35
v_cvt_pk_bf16_f32 v94, v36, v37
v_cvt_pk_bf16_f32 v95, v38, v39
v_cvt_pk_bf16_f32 v96, v40, v41
v_cvt_pk_bf16_f32 v97, v42, v43
v_cvt_pk_bf16_f32 v98, v44, v45
v_cvt_pk_bf16_f32 v99, v46, v47
v_cvt_pk_bf16_f32 v100, v48, v49
v_cvt_pk_bf16_f32 v101, v50, v51
v_cvt_pk_bf16_f32 v102, v52, v53
v_cvt_pk_bf16_f32 v103, v54, v55
v_cvt_pk_bf16_f32 v104, v56, v57
v_cvt_pk_bf16_f32 v105, v58, v59
v_cvt_pk_bf16_f32 v106, v60, v61
v_cvt_pk_bf16_f32 v107, v62, v63
v_cvt_pk_bf16_f32 v108, v64, v65
v_cvt_pk_bf16_f32 v109, v66, v67
v_cvt_pk_bf16_f32 v110, v68, v69
v_cvt_pk_bf16_f32 v111, v70, v71
v_cvt_pk_bf16_f32 v112, v72, v73
v_cvt_pk_bf16_f32 v113, v74, v75
v_cvt_pk_bf16_f32 v114, v76, v77
v_cvt_pk_bf16_f32 v115, v78, v79
v_cvt_pk_bf16_f32 v116, v80, v81
v_cvt_pk_bf16_f32 v117, v82, v83
v_cvt_pk_bf16_f32 v118, v84, v85
v_cvt_pk_bf16_f32 v119, v86, v87
s_nop 1
v_permlane32_swap_b32 v88, v90
v_permlane32_swap_b32 v89, v91
v_permlane32_swap_b32 v92, v94
v_permlane32_swap_b32 v93, v95
v_permlane32_swap_b32 v96, v98
v_permlane32_swap_b32 v97, v99
v_permlane32_swap_b32 v100, v102
v_permlane32_swap_b32 v101, v103
v_permlane32_swap_b32 v104, v106
v_permlane32_swap_b32 v105, v107
v_permlane32_swap_b32 v108, v110
v_permlane32_swap_b32 v109, v111
v_permlane32_swap_b32 v112, v114
v_permlane32_swap_b32 v113, v115
v_permlane32_swap_b32 v116, v118
v_permlane32_swap_b32 v117, v119
s_barrier
ds_write_b128 v2, v[88:91] offset:0
ds_write_b128 v3, v[104:107] offset:0
ds_write_b128 v2, v[92:95] offset:1024
ds_write_b128 v3, v[108:111] offset:1024
ds_write_b128 v2, v[96:99] offset:2048
ds_write_b128 v3, v[112:115] offset:2048
ds_write_b128 v2, v[100:103] offset:3072
ds_write_b128 v3, v[116:119] offset:3072
s_add_u32 s3, s44, 131072
v_add_u32 v2, s3, v1
s_add_u32 s3, s44, 49152
v_add_u32 v3, s3, v1
v_add_u32 v21, 65536, v3
s_waitcnt lgkmcnt(0)
s_barrier
ds_read_b128 v[224:227], v2 offset:0
ds_read_b128 v[228:231], v2 offset:1024
ds_read_b128 v[232:235], v2 offset:2048
ds_read_b128 v[236:239], v2 offset:3072
ds_read_b128 v[240:243], v3 offset:0
ds_read_b128 v[244:247], v3 offset:1024
ds_read_b128 v[248:251], v3 offset:2048
ds_read_b128 v[252:255], v3 offset:3072
s_waitcnt lgkmcnt(0)
ds_read_b128 v[120:123], v2 offset:16384
ds_read_b128 v[124:127], v2 offset:17408
ds_read_b128 v[128:131], v2 offset:18432
ds_read_b128 v[132:135], v2 offset:19456
ds_read_b128 v[136:139], v21 offset:0
ds_read_b128 v[140:143], v21 offset:1024
ds_read_b128 v[144:147], v21 offset:2048
ds_read_b128 v[148:151], v21 offset:3072
s_waitcnt lgkmcnt(0)
v_xor_b32 v11, 64, v223
v_mov_b32 v10, v223
s_lshl_b32 s3, s53, 6
v_xor_b32 v12, s3, v223
s_waitcnt vmcnt(8)
s_barrier
ds_read_b64_tr_b16 v[168:169], v10 offset:0
ds_read_b64_tr_b16 v[170:171], v10 offset:512
ds_read_b64_tr_b16 v[172:173], v11 offset:0
ds_read_b64_tr_b16 v[174:175], v11 offset:512
ds_read_b64_tr_b16 v[176:177], v10 offset:2048
ds_read_b64_tr_b16 v[178:179], v10 offset:2560
ds_read_b64_tr_b16 v[180:181], v11 offset:2048
ds_read_b64_tr_b16 v[182:183], v11 offset:2560
ds_read_b64_tr_b16 v[184:185], v10 offset:4096
ds_read_b64_tr_b16 v[186:187], v10 offset:4608
ds_read_b64_tr_b16 v[188:189], v11 offset:4096
ds_read_b64_tr_b16 v[190:191], v11 offset:4608
ds_read_b64_tr_b16 v[192:193], v10 offset:6144
ds_read_b64_tr_b16 v[194:195], v10 offset:6656
s_waitcnt lgkmcnt(12)
v_mfma_f32_32x32x16_bf16 v[24:39], v[168:171], v[224:227], 0
s_add_u32 s3, s55, 49152
s_mov_b32 m0, s3
s_add_u32 s50, s60, 147584
buffer_load_dwordx4 v222, s[56:59], s50 offen lds
ds_read_b64_tr_b16 v[196:197], v11 offset:6144
ds_read_b64_tr_b16 v[198:199], v11 offset:6656
s_waitcnt lgkmcnt(12)
v_mfma_f32_32x32x16_bf16 v[40:55], v[172:175], v[224:227], 0
s_add_u32 s3, s55, 50176
s_mov_b32 m0, s3
s_add_u32 s50, s60, 156800
buffer_load_dwordx4 v222, s[56:59], s50 offen lds
ds_read_b64_tr_b16 v[168:169], v10 offset:8192
ds_read_b64_tr_b16 v[170:171], v10 offset:8704
s_waitcnt lgkmcnt(12)
v_mfma_f32_32x32x16_bf16 v[24:39], v[176:179], v[228:231], v[24:39]
s_add_u32 s3, s55, 51200
s_mov_b32 m0, s3
s_add_u32 s50, s60, 166016
buffer_load_dwordx4 v222, s[56:59], s50 offen lds
ds_read_b64_tr_b16 v[172:173], v11 offset:8192
ds_read_b64_tr_b16 v[174:175], v11 offset:8704
s_waitcnt lgkmcnt(12)
v_mfma_f32_32x32x16_bf16 v[40:55], v[180:183], v[228:231], v[40:55]
s_add_u32 s3, s55, 52224
s_mov_b32 m0, s3
s_add_u32 s50, s60, 175232
buffer_load_dwordx4 v222, s[56:59], s50 offen lds
ds_read_b64_tr_b16 v[176:177], v10 offset:10240
ds_read_b64_tr_b16 v[178:179], v10 offset:10752
s_waitcnt lgkmcnt(12)
v_mfma_f32_32x32x16_bf16 v[24:39], v[184:187], v[232:235], v[24:39]
ds_read_b64_tr_b16 v[180:181], v11 offset:10240
ds_read_b64_tr_b16 v[182:183], v11 offset:10752
s_waitcnt lgkmcnt(12)
v_mfma_f32_32x32x16_bf16 v[40:55], v[188:191], v[232:235], v[40:55]
ds_read_b64_tr_b16 v[184:185], v10 offset:12288
ds_read_b64_tr_b16 v[186:187], v10 offset:12800
s_waitcnt lgkmcnt(12)
v_mfma_f32_32x32x16_bf16 v[24:39], v[192:195], v[236:239], v[24:39]
ds_read_b64_tr_b16 v[188:189], v11 offset:12288
ds_read_b64_tr_b16 v[190:191], v11 offset:12800
s_waitcnt lgkmcnt(12)
v_mfma_f32_32x32x16_bf16 v[40:55], v[196:199], v[236:239], v[40:55]
ds_read_b64_tr_b16 v[192:193], v10 offset:14336
ds_read_b64_tr_b16 v[194:195], v10 offset:14848
s_waitcnt lgkmcnt(12)
v_mfma_f32_32x32x16_bf16 v[24:39], v[168:171], v[240:243], v[24:39]
ds_read_b64_tr_b16 v[196:197], v11 offset:14336
ds_read_b64_tr_b16 v[198:199], v11 offset:14848
s_waitcnt lgkmcnt(12)
v_mfma_f32_32x32x16_bf16 v[40:55], v[172:175], v[240:243], v[40:55]
s_waitcnt lgkmcnt(10)
v_mfma_f32_32x32x16_bf16 v[24:39], v[176:179], v[244:247], v[24:39]
s_waitcnt lgkmcnt(8)
v_mfma_f32_32x32x16_bf16 v[40:55], v[180:183], v[244:247], v[40:55]
s_waitcnt lgkmcnt(0)
s_waitcnt vmcnt(8)
s_barrier
ds_read_b64_tr_b16 v[168:169], v10 offset:16384
ds_read_b64_tr_b16 v[170:171], v10 offset:16896
ds_read_b64_tr_b16 v[172:173], v11 offset:16384
ds_read_b64_tr_b16 v[174:175], v11 offset:16896
ds_read_b64_tr_b16 v[176:177], v10 offset:18432
ds_read_b64_tr_b16 v[178:179], v10 offset:18944
v_mfma_f32_32x32x16_bf16 v[24:39], v[184:187], v[248:251], v[24:39]
s_add_u32 s3, s55, 0
s_mov_b32 m0, s3
s_add_u32 s50, s60, 256
buffer_load_dwordx4 v222, s[56:59], s50 offen lds
ds_read_b64_tr_b16 v[180:181], v11 offset:18432
ds_read_b64_tr_b16 v[182:183], v11 offset:18944
v_mfma_f32_32x32x16_bf16 v[40:55], v[188:191], v[248:251], v[40:55]
s_add_u32 s3, s55, 1024
s_mov_b32 m0, s3
s_add_u32 s50, s60, 9472
buffer_load_dwordx4 v222, s[56:59], s50 offen lds
v_mfma_f32_32x32x16_bf16 v[24:39], v[192:195], v[252:255], v[24:39]
s_add_u32 s3, s55, 2048
s_mov_b32 m0, s3
s_add_u32 s50, s60, 18688
buffer_load_dwordx4 v222, s[56:59], s50 offen lds
v_mfma_f32_32x32x16_bf16 v[40:55], v[196:199], v[252:255], v[40:55]
s_add_u32 s3, s55, 3072
s_mov_b32 m0, s3
s_add_u32 s50, s60, 27904
buffer_load_dwordx4 v222, s[56:59], s50 offen lds
ds_read_b64_tr_b16 v[184:185], v10 offset:20480
ds_read_b64_tr_b16 v[186:187], v10 offset:20992
ds_read_b64_tr_b16 v[188:189], v11 offset:20480
ds_read_b64_tr_b16 v[190:191], v11 offset:20992
ds_read_b64_tr_b16 v[192:193], v10 offset:22528
ds_read_b64_tr_b16 v[194:195], v10 offset:23040
s_waitcnt lgkmcnt(12)
v_mfma_f32_32x32x16_bf16 v[24:39], v[168:171], v[120:123], v[24:39]
ds_read_b64_tr_b16 v[196:197], v11 offset:22528
ds_read_b64_tr_b16 v[198:199], v11 offset:23040
s_waitcnt lgkmcnt(12)
v_mfma_f32_32x32x16_bf16 v[40:55], v[172:175], v[120:123], v[40:55]
ds_read_b64_tr_b16 v[168:169], v10 offset:24576
ds_read_b64_tr_b16 v[170:171], v10 offset:25088
s_waitcnt lgkmcnt(12)
v_mfma_f32_32x32x16_bf16 v[24:39], v[176:179], v[124:127], v[24:39]
ds_read_b64_tr_b16 v[172:173], v11 offset:24576
ds_read_b64_tr_b16 v[174:175], v11 offset:25088
s_waitcnt lgkmcnt(12)
v_mfma_f32_32x32x16_bf16 v[40:55], v[180:183], v[124:127], v[40:55]
ds_read_b64_tr_b16 v[176:177], v10 offset:26624
ds_read_b64_tr_b16 v[178:179], v10 offset:27136
s_waitcnt lgkmcnt(12)
v_mfma_f32_32x32x16_bf16 v[24:39], v[184:187], v[128:131], v[24:39]
ds_read_b64_tr_b16 v[180:181], v11 offset:26624
ds_read_b64_tr_b16 v[182:183], v11 offset:27136
s_waitcnt lgkmcnt(12)
v_mfma_f32_32x32x16_bf16 v[40:55], v[188:191], v[128:131], v[40:55]
ds_read_b64_tr_b16 v[184:185], v10 offset:28672
ds_read_b64_tr_b16 v[186:187], v10 offset:29184
s_waitcnt lgkmcnt(12)
v_mfma_f32_32x32x16_bf16 v[24:39], v[192:195], v[132:135], v[24:39]
ds_read_b64_tr_b16 v[188:189], v11 offset:28672
ds_read_b64_tr_b16 v[190:191], v11 offset:29184
s_waitcnt lgkmcnt(12)
v_mfma_f32_32x32x16_bf16 v[40:55], v[196:199], v[132:135], v[40:55]
ds_read_b64_tr_b16 v[192:193], v10 offset:30720
ds_read_b64_tr_b16 v[194:195], v10 offset:31232
s_waitcnt lgkmcnt(12)
v_mfma_f32_32x32x16_bf16 v[24:39], v[168:171], v[136:139], v[24:39]
ds_read_b64_tr_b16 v[196:197], v11 offset:30720
ds_read_b64_tr_b16 v[198:199], v11 offset:31232
s_waitcnt lgkmcnt(12)
v_mfma_f32_32x32x16_bf16 v[40:55], v[172:175], v[136:139], v[40:55]
s_waitcnt lgkmcnt(10)
v_mfma_f32_32x32x16_bf16 v[24:39], v[176:179], v[140:143], v[24:39]
s_waitcnt lgkmcnt(8)
v_mfma_f32_32x32x16_bf16 v[40:55], v[180:183], v[140:143], v[40:55]
s_waitcnt lgkmcnt(0)
s_waitcnt vmcnt(8)
s_barrier
ds_read_b64_tr_b16 v[168:169], v10 offset:32768
ds_read_b64_tr_b16 v[170:171], v10 offset:33280
ds_read_b64_tr_b16 v[172:173], v11 offset:32768
ds_read_b64_tr_b16 v[174:175], v11 offset:33280
ds_read_b64_tr_b16 v[176:177], v10 offset:34816
ds_read_b64_tr_b16 v[178:179], v10 offset:35328
v_mfma_f32_32x32x16_bf16 v[24:39], v[184:187], v[144:147], v[24:39]
s_add_u32 s3, s55, 16384
s_mov_b32 m0, s3
s_add_u32 s50, s60, 147712
buffer_load_dwordx4 v222, s[56:59], s50 offen lds
ds_read_b64_tr_b16 v[180:181], v11 offset:34816
ds_read_b64_tr_b16 v[182:183], v11 offset:35328
v_mfma_f32_32x32x16_bf16 v[40:55], v[188:191], v[144:147], v[40:55]
s_add_u32 s3, s55, 17408
s_mov_b32 m0, s3
s_add_u32 s50, s60, 156928
buffer_load_dwordx4 v222, s[56:59], s50 offen lds
v_mfma_f32_32x32x16_bf16 v[24:39], v[192:195], v[148:151], v[24:39]
s_add_u32 s3, s55, 18432
s_mov_b32 m0, s3
s_add_u32 s50, s60, 166144
buffer_load_dwordx4 v222, s[56:59], s50 offen lds
v_mfma_f32_32x32x16_bf16 v[40:55], v[196:199], v[148:151], v[40:55]
s_add_u32 s3, s55, 19456
s_mov_b32 m0, s3
s_add_u32 s50, s60, 175360
buffer_load_dwordx4 v222, s[56:59], s50 offen lds
ds_read_b64_tr_b16 v[184:185], v10 offset:36864
ds_read_b64_tr_b16 v[186:187], v10 offset:37376
ds_read_b64_tr_b16 v[188:189], v11 offset:36864
ds_read_b64_tr_b16 v[190:191], v11 offset:37376
ds_read_b64_tr_b16 v[192:193], v10 offset:38912
ds_read_b64_tr_b16 v[194:195], v10 offset:39424
s_waitcnt lgkmcnt(12)
v_mfma_f32_32x32x16_bf16 v[56:71], v[168:171], v[224:227], 0
ds_read_b64_tr_b16 v[196:197], v11 offset:38912
ds_read_b64_tr_b16 v[198:199], v11 offset:39424
s_waitcnt lgkmcnt(12)
v_mfma_f32_32x32x16_bf16 v[72:87], v[172:175], v[224:227], 0
ds_read_b64_tr_b16 v[168:169], v10 offset:40960
ds_read_b64_tr_b16 v[170:171], v10 offset:41472
s_waitcnt lgkmcnt(12)
v_mfma_f32_32x32x16_bf16 v[56:71], v[176:179], v[228:231], v[56:71]
ds_read_b64_tr_b16 v[172:173], v11 offset:40960
ds_read_b64_tr_b16 v[174:175], v11 offset:41472
s_waitcnt lgkmcnt(12)
v_mfma_f32_32x32x16_bf16 v[72:87], v[180:183], v[228:231], v[72:87]
ds_read_b64_tr_b16 v[176:177], v10 offset:43008
ds_read_b64_tr_b16 v[178:179], v10 offset:43520
s_waitcnt lgkmcnt(12)
v_mfma_f32_32x32x16_bf16 v[56:71], v[184:187], v[232:235], v[56:71]
ds_read_b64_tr_b16 v[180:181], v11 offset:43008
ds_read_b64_tr_b16 v[182:183], v11 offset:43520
s_waitcnt lgkmcnt(12)
v_mfma_f32_32x32x16_bf16 v[72:87], v[188:191], v[232:235], v[72:87]
v_cvt_pk_bf16_f32 v88, v24, v25
v_cvt_pk_bf16_f32 v89, v26, v27
v_cvt_pk_bf16_f32 v90, v28, v29
v_cvt_pk_bf16_f32 v91, v30, v31
v_cvt_pk_bf16_f32 v92, v32, v33
v_cvt_pk_bf16_f32 v93, v34, v35
v_cvt_pk_bf16_f32 v94, v36, v37
v_cvt_pk_bf16_f32 v95, v38, v39
v_cvt_pk_bf16_f32 v96, v40, v41
v_cvt_pk_bf16_f32 v97, v42, v43
v_cvt_pk_bf16_f32 v98, v44, v45
v_cvt_pk_bf16_f32 v99, v46, v47
v_cvt_pk_bf16_f32 v100, v48, v49
v_cvt_pk_bf16_f32 v101, v50, v51
v_cvt_pk_bf16_f32 v102, v52, v53
v_cvt_pk_bf16_f32 v103, v54, v55
s_mul_i32 s61, s53, 20480
s_add_u32 s61, s61, 0
buffer_store_dwordx4 v[88:91], v1, s[24:27], s61 offen offset:0 sc1
buffer_store_dwordx4 v[92:95], v1, s[24:27], s61 offen offset:1024 sc1
buffer_store_dwordx4 v[96:99], v1, s[24:27], s61 offen offset:2048 sc1
buffer_store_dwordx4 v[100:103], v1, s[24:27], s61 offen offset:3072 sc1
ds_read_b64_tr_b16 v[184:185], v10 offset:45056
ds_read_b64_tr_b16 v[186:187], v10 offset:45568
s_waitcnt lgkmcnt(12)
v_mfma_f32_32x32x16_bf16 v[56:71], v[192:195], v[236:239], v[56:71]
ds_read_b64_tr_b16 v[188:189], v11 offset:45056
ds_read_b64_tr_b16 v[190:191], v11 offset:45568
s_waitcnt lgkmcnt(12)
v_mfma_f32_32x32x16_bf16 v[72:87], v[196:199], v[236:239], v[72:87]
ds_read_b64_tr_b16 v[192:193], v10 offset:47104
ds_read_b64_tr_b16 v[194:195], v10 offset:47616
s_waitcnt lgkmcnt(12)
v_mfma_f32_32x32x16_bf16 v[56:71], v[168:171], v[240:243], v[56:71]
ds_read_b64_tr_b16 v[196:197], v11 offset:47104
ds_read_b64_tr_b16 v[198:199], v11 offset:47616
s_waitcnt lgkmcnt(12)
v_mfma_f32_32x32x16_bf16 v[72:87], v[172:175], v[240:243], v[72:87]
s_waitcnt lgkmcnt(10)
v_mfma_f32_32x32x16_bf16 v[56:71], v[176:179], v[244:247], v[56:71]
s_waitcnt lgkmcnt(8)
v_mfma_f32_32x32x16_bf16 v[72:87], v[180:183], v[244:247], v[72:87]
s_waitcnt lgkmcnt(0)
s_waitcnt vmcnt(12)
s_barrier
ds_read_b64_tr_b16 v[168:169], v10 offset:49152
ds_read_b64_tr_b16 v[170:171], v10 offset:49664
ds_read_b64_tr_b16 v[172:173], v11 offset:49152
ds_read_b64_tr_b16 v[174:175], v11 offset:49664
ds_read_b64_tr_b16 v[176:177], v10 offset:51200
ds_read_b64_tr_b16 v[178:179], v10 offset:51712
v_mfma_f32_32x32x16_bf16 v[56:71], v[184:187], v[248:251], v[56:71]
s_add_u32 s3, s55, 32768
s_mov_b32 m0, s3
s_add_u32 s50, s60, 384
buffer_load_dwordx4 v222, s[56:59], s50 offen lds
ds_read_b64_tr_b16 v[180:181], v11 offset:51200
ds_read_b64_tr_b16 v[182:183], v11 offset:51712
v_mfma_f32_32x32x16_bf16 v[72:87], v[188:191], v[248:251], v[72:87]
s_add_u32 s3, s55, 33792
s_mov_b32 m0, s3
s_add_u32 s50, s60, 9600
buffer_load_dwordx4 v222, s[56:59], s50 offen lds
v_mfma_f32_32x32x16_bf16 v[56:71], v[192:195], v[252:255], v[56:71]
s_add_u32 s3, s55, 34816
s_mov_b32 m0, s3
s_add_u32 s50, s60, 18816
buffer_load_dwordx4 v222, s[56:59], s50 offen lds
v_mfma_f32_32x32x16_bf16 v[72:87], v[196:199], v[252:255], v[72:87]
s_add_u32 s3, s55, 35840
s_mov_b32 m0, s3
s_add_u32 s50, s60, 28032
buffer_load_dwordx4 v222, s[56:59], s50 offen lds
ds_read_b64_tr_b16 v[184:185], v10 offset:53248
ds_read_b64_tr_b16 v[186:187], v10 offset:53760
ds_read_b64_tr_b16 v[188:189], v11 offset:53248
ds_read_b64_tr_b16 v[190:191], v11 offset:53760
ds_read_b64_tr_b16 v[192:193], v10 offset:55296
ds_read_b64_tr_b16 v[194:195], v10 offset:55808
s_waitcnt lgkmcnt(12)
v_mfma_f32_32x32x16_bf16 v[56:71], v[168:171], v[120:123], v[56:71]
ds_read_b64_tr_b16 v[196:197], v11 offset:55296
ds_read_b64_tr_b16 v[198:199], v11 offset:55808
s_waitcnt lgkmcnt(12)
v_mfma_f32_32x32x16_bf16 v[72:87], v[172:175], v[120:123], v[72:87]
ds_read_b64_tr_b16 v[168:169], v10 offset:57344
ds_read_b64_tr_b16 v[170:171], v10 offset:57856
s_waitcnt lgkmcnt(12)
v_mfma_f32_32x32x16_bf16 v[56:71], v[176:179], v[124:127], v[56:71]
ds_read_b64_tr_b16 v[172:173], v11 offset:57344
ds_read_b64_tr_b16 v[174:175], v11 offset:57856
s_waitcnt lgkmcnt(12)
v_mfma_f32_32x32x16_bf16 v[72:87], v[180:183], v[124:127], v[72:87]
ds_read_b64_tr_b16 v[176:177], v10 offset:59392
ds_read_b64_tr_b16 v[178:179], v10 offset:59904
s_waitcnt lgkmcnt(12)
v_mfma_f32_32x32x16_bf16 v[56:71], v[184:187], v[128:131], v[56:71]
ds_read_b64_tr_b16 v[180:181], v11 offset:59392
ds_read_b64_tr_b16 v[182:183], v11 offset:59904
s_waitcnt lgkmcnt(12)
v_mfma_f32_32x32x16_bf16 v[72:87], v[188:191], v[128:131], v[72:87]
ds_read_b64_tr_b16 v[184:185], v10 offset:61440
ds_read_b64_tr_b16 v[186:187], v10 offset:61952
s_waitcnt lgkmcnt(12)
v_mfma_f32_32x32x16_bf16 v[56:71], v[192:195], v[132:135], v[56:71]
ds_read_b64_tr_b16 v[188:189], v11 offset:61440
ds_read_b64_tr_b16 v[190:191], v11 offset:61952
s_waitcnt lgkmcnt(12)
v_mfma_f32_32x32x16_bf16 v[72:87], v[196:199], v[132:135], v[72:87]
ds_read_b64_tr_b16 v[192:193], v10 offset:63488
ds_read_b64_tr_b16 v[194:195], v10 offset:64000
s_waitcnt lgkmcnt(12)
v_mfma_f32_32x32x16_bf16 v[56:71], v[168:171], v[136:139], v[56:71]
ds_read_b64_tr_b16 v[196:197], v11 offset:63488
ds_read_b64_tr_b16 v[198:199], v11 offset:64000
s_waitcnt lgkmcnt(12)
v_mfma_f32_32x32x16_bf16 v[72:87], v[172:175], v[136:139], v[72:87]
s_waitcnt lgkmcnt(10)
v_mfma_f32_32x32x16_bf16 v[56:71], v[176:179], v[140:143], v[56:71]
s_waitcnt lgkmcnt(8)
v_mfma_f32_32x32x16_bf16 v[72:87], v[180:183], v[140:143], v[72:87]
s_waitcnt lgkmcnt(0)
s_waitcnt vmcnt(12)
s_barrier
ds_read_b64_tr_b16 v[168:169], v10 offset:0
ds_read_b64_tr_b16 v[170:171], v10 offset:512
ds_read_b64_tr_b16 v[172:173], v11 offset:0
ds_read_b64_tr_b16 v[174:175], v11 offset:512
ds_read_b64_tr_b16 v[176:177], v10 offset:2048
ds_read_b64_tr_b16 v[178:179], v10 offset:2560
v_mfma_f32_32x32x16_bf16 v[56:71], v[184:187], v[144:147], v[56:71]
s_add_u32 s3, s55, 49152
s_mov_b32 m0, s3
s_add_u32 s50, s60, 147840
buffer_load_dwordx4 v222, s[56:59], s50 offen lds
ds_read_b64_tr_b16 v[180:181], v11 offset:2048
ds_read_b64_tr_b16 v[182:183], v11 offset:2560
v_mfma_f32_32x32x16_bf16 v[72:87], v[188:191], v[144:147], v[72:87]
s_add_u32 s3, s55, 50176
s_mov_b32 m0, s3
s_add_u32 s50, s60, 157056
buffer_load_dwordx4 v222, s[56:59], s50 offen lds
v_mfma_f32_32x32x16_bf16 v[56:71], v[192:195], v[148:151], v[56:71]
s_add_u32 s3, s55, 51200
s_mov_b32 m0, s3
s_add_u32 s50, s60, 166272
buffer_load_dwordx4 v222, s[56:59], s50 offen lds
v_mfma_f32_32x32x16_bf16 v[72:87], v[196:199], v[148:151], v[72:87]
s_add_u32 s3, s55, 52224
s_mov_b32 m0, s3
s_add_u32 s50, s60, 175488
buffer_load_dwordx4 v222, s[56:59], s50 offen lds
ds_read_b64_tr_b16 v[184:185], v10 offset:4096
ds_read_b64_tr_b16 v[186:187], v10 offset:4608
ds_read_b64_tr_b16 v[188:189], v11 offset:4096
ds_read_b64_tr_b16 v[190:191], v11 offset:4608
ds_read_b64_tr_b16 v[192:193], v10 offset:6144
ds_read_b64_tr_b16 v[194:195], v10 offset:6656
s_waitcnt lgkmcnt(12)
v_mfma_f32_32x32x16_bf16 v[24:39], v[168:171], v[224:227], 0
ds_read_b64_tr_b16 v[196:197], v11 offset:6144
ds_read_b64_tr_b16 v[198:199], v11 offset:6656
s_waitcnt lgkmcnt(12)
v_mfma_f32_32x32x16_bf16 v[40:55], v[172:175], v[224:227], 0
ds_read_b64_tr_b16 v[168:169], v10 offset:8192
ds_read_b64_tr_b16 v[170:171], v10 offset:8704
s_waitcnt lgkmcnt(12)
v_mfma_f32_32x32x16_bf16 v[24:39], v[176:179], v[228:231], v[24:39]
ds_read_b64_tr_b16 v[172:173], v11 offset:8192
ds_read_b64_tr_b16 v[174:175], v11 offset:8704
s_waitcnt lgkmcnt(12)
v_mfma_f32_32x32x16_bf16 v[40:55], v[180:183], v[228:231], v[40:55]
ds_read_b64_tr_b16 v[176:177], v10 offset:10240
ds_read_b64_tr_b16 v[178:179], v10 offset:10752
s_waitcnt lgkmcnt(12)
v_mfma_f32_32x32x16_bf16 v[24:39], v[184:187], v[232:235], v[24:39]
ds_read_b64_tr_b16 v[180:181], v11 offset:10240
ds_read_b64_tr_b16 v[182:183], v11 offset:10752
s_waitcnt lgkmcnt(12)
v_mfma_f32_32x32x16_bf16 v[40:55], v[188:191], v[232:235], v[40:55]
v_cvt_pk_bf16_f32 v88, v56, v57
v_cvt_pk_bf16_f32 v89, v58, v59
v_cvt_pk_bf16_f32 v90, v60, v61
v_cvt_pk_bf16_f32 v91, v62, v63
v_cvt_pk_bf16_f32 v92, v64, v65
v_cvt_pk_bf16_f32 v93, v66, v67
v_cvt_pk_bf16_f32 v94, v68, v69
v_cvt_pk_bf16_f32 v95, v70, v71
v_cvt_pk_bf16_f32 v96, v72, v73
v_cvt_pk_bf16_f32 v97, v74, v75
v_cvt_pk_bf16_f32 v98, v76, v77
v_cvt_pk_bf16_f32 v99, v78, v79
v_cvt_pk_bf16_f32 v100, v80, v81
v_cvt_pk_bf16_f32 v101, v82, v83
v_cvt_pk_bf16_f32 v102, v84, v85
v_cvt_pk_bf16_f32 v103, v86, v87
s_mul_i32 s61, s53, 20480
s_add_u32 s61, s61, 4096
buffer_store_dwordx4 v[88:91], v1, s[24:27], s61 offen offset:0 sc1
buffer_store_dwordx4 v[92:95], v1, s[24:27], s61 offen offset:1024 sc1
buffer_store_dwordx4 v[96:99], v1, s[24:27], s61 offen offset:2048 sc1
buffer_store_dwordx4 v[100:103], v1, s[24:27], s61 offen offset:3072 sc1
ds_read_b64_tr_b16 v[184:185], v10 offset:12288
ds_read_b64_tr_b16 v[186:187], v10 offset:12800
s_waitcnt lgkmcnt(12)
v_mfma_f32_32x32x16_bf16 v[24:39], v[192:195], v[236:239], v[24:39]
ds_read_b64_tr_b16 v[188:189], v11 offset:12288
ds_read_b64_tr_b16 v[190:191], v11 offset:12800
s_waitcnt lgkmcnt(12)
v_mfma_f32_32x32x16_bf16 v[40:55], v[196:199], v[236:239], v[40:55]
ds_read_b64_tr_b16 v[192:193], v10 offset:14336
ds_read_b64_tr_b16 v[194:195], v10 offset:14848
s_waitcnt lgkmcnt(12)
v_mfma_f32_32x32x16_bf16 v[24:39], v[168:171], v[240:243], v[24:39]
ds_read_b64_tr_b16 v[196:197], v11 offset:14336
ds_read_b64_tr_b16 v[198:199], v11 offset:14848
s_waitcnt lgkmcnt(12)
v_mfma_f32_32x32x16_bf16 v[40:55], v[172:175], v[240:243], v[40:55]
s_waitcnt lgkmcnt(10)
v_mfma_f32_32x32x16_bf16 v[24:39], v[176:179], v[244:247], v[24:39]
s_waitcnt lgkmcnt(8)
v_mfma_f32_32x32x16_bf16 v[40:55], v[180:183], v[244:247], v[40:55]
s_waitcnt lgkmcnt(0)
s_waitcnt vmcnt(16)
s_barrier
ds_read_b64_tr_b16 v[168:169], v10 offset:16384
ds_read_b64_tr_b16 v[170:171], v10 offset:16896
ds_read_b64_tr_b16 v[172:173], v11 offset:16384
ds_read_b64_tr_b16 v[174:175], v11 offset:16896
ds_read_b64_tr_b16 v[176:177], v10 offset:18432
ds_read_b64_tr_b16 v[178:179], v10 offset:18944
v_mfma_f32_32x32x16_bf16 v[24:39], v[184:187], v[248:251], v[24:39]
s_add_u32 s3, s55, 0
s_mov_b32 m0, s3
s_add_u32 s50, s37, 0
buffer_load_dwordx4 v222, s[56:59], s50 offen lds
ds_read_b64_tr_b16 v[180:181], v11 offset:18432
ds_read_b64_tr_b16 v[182:183], v11 offset:18944
v_mfma_f32_32x32x16_bf16 v[40:55], v[188:191], v[248:251], v[40:55]
s_add_u32 s3, s55, 1024
s_mov_b32 m0, s3
s_add_u32 s50, s37, 9216
buffer_load_dwordx4 v222, s[56:59], s50 offen lds
v_mfma_f32_32x32x16_bf16 v[24:39], v[192:195], v[252:255], v[24:39]
s_add_u32 s3, s55, 2048
s_mov_b32 m0, s3
s_add_u32 s50, s37, 18432
buffer_load_dwordx4 v222, s[56:59], s50 offen lds
v_mfma_f32_32x32x16_bf16 v[40:55], v[196:199], v[252:255], v[40:55]
s_add_u32 s3, s55, 3072
s_mov_b32 m0, s3
s_add_u32 s50, s37, 27648
buffer_load_dwordx4 v222, s[56:59], s50 offen lds
ds_read_b64_tr_b16 v[184:185], v10 offset:20480
ds_read_b64_tr_b16 v[186:187], v10 offset:20992
ds_read_b64_tr_b16 v[188:189], v11 offset:20480
ds_read_b64_tr_b16 v[190:191], v11 offset:20992
ds_read_b64_tr_b16 v[192:193], v10 offset:22528
ds_read_b64_tr_b16 v[194:195], v10 offset:23040
s_waitcnt lgkmcnt(12)
v_mfma_f32_32x32x16_bf16 v[24:39], v[168:171], v[120:123], v[24:39]
ds_read_b64_tr_b16 v[196:197], v11 offset:22528
ds_read_b64_tr_b16 v[198:199], v11 offset:23040
s_waitcnt lgkmcnt(12)
v_mfma_f32_32x32x16_bf16 v[40:55], v[172:175], v[120:123], v[40:55]
ds_read_b64_tr_b16 v[168:169], v10 offset:24576
ds_read_b64_tr_b16 v[170:171], v10 offset:25088
s_waitcnt lgkmcnt(12)
v_mfma_f32_32x32x16_bf16 v[24:39], v[176:179], v[124:127], v[24:39]
ds_read_b64_tr_b16 v[172:173], v11 offset:24576
ds_read_b64_tr_b16 v[174:175], v11 offset:25088
s_waitcnt lgkmcnt(12)
v_mfma_f32_32x32x16_bf16 v[40:55], v[180:183], v[124:127], v[40:55]
ds_read_b64_tr_b16 v[176:177], v10 offset:26624
ds_read_b64_tr_b16 v[178:179], v10 offset:27136
s_waitcnt lgkmcnt(12)
v_mfma_f32_32x32x16_bf16 v[24:39], v[184:187], v[128:131], v[24:39]
ds_read_b64_tr_b16 v[180:181], v11 offset:26624
ds_read_b64_tr_b16 v[182:183], v11 offset:27136
s_waitcnt lgkmcnt(12)
v_mfma_f32_32x32x16_bf16 v[40:55], v[188:191], v[128:131], v[40:55]
ds_read_b64_tr_b16 v[184:185], v10 offset:28672
ds_read_b64_tr_b16 v[186:187], v10 offset:29184
s_waitcnt lgkmcnt(12)
v_mfma_f32_32x32x16_bf16 v[24:39], v[192:195], v[132:135], v[24:39]
ds_read_b64_tr_b16 v[188:189], v11 offset:28672
ds_read_b64_tr_b16 v[190:191], v11 offset:29184
s_waitcnt lgkmcnt(12)
v_mfma_f32_32x32x16_bf16 v[40:55], v[196:199], v[132:135], v[40:55]
ds_read_b64_tr_b16 v[192:193], v10 offset:30720
ds_read_b64_tr_b16 v[194:195], v10 offset:31232
s_waitcnt lgkmcnt(12)
v_mfma_f32_32x32x16_bf16 v[24:39], v[168:171], v[136:139], v[24:39]
ds_read_b64_tr_b16 v[196:197], v11 offset:30720
ds_read_b64_tr_b16 v[198:199], v11 offset:31232
s_waitcnt lgkmcnt(12)
v_mfma_f32_32x32x16_bf16 v[40:55], v[172:175], v[136:139], v[40:55]
s_waitcnt lgkmcnt(10)
v_mfma_f32_32x32x16_bf16 v[24:39], v[176:179], v[140:143], v[24:39]
s_waitcnt lgkmcnt(8)
v_mfma_f32_32x32x16_bf16 v[40:55], v[180:183], v[140:143], v[40:55]
s_waitcnt lgkmcnt(0)
s_waitcnt vmcnt(12)
s_barrier
ds_read_b64_tr_b16 v[168:169], v10 offset:32768
ds_read_b64_tr_b16 v[170:171], v10 offset:33280
ds_read_b64_tr_b16 v[172:173], v11 offset:32768
ds_read_b64_tr_b16 v[174:175], v11 offset:33280
ds_read_b64_tr_b16 v[176:177], v10 offset:34816
ds_read_b64_tr_b16 v[178:179], v10 offset:35328
v_mfma_f32_32x32x16_bf16 v[24:39], v[184:187], v[144:147], v[24:39]
s_add_u32 s3, s55, 16384
s_mov_b32 m0, s3
s_add_u32 s50, s37, 147456
buffer_load_dwordx4 v222, s[56:59], s50 offen lds
ds_read_b64_tr_b16 v[180:181], v11 offset:34816
ds_read_b64_tr_b16 v[182:183], v11 offset:35328
v_mfma_f32_32x32x16_bf16 v[40:55], v[188:191], v[144:147], v[40:55]
s_add_u32 s3, s55, 17408
s_mov_b32 m0, s3
s_add_u32 s50, s37, 156672
buffer_load_dwordx4 v222, s[56:59], s50 offen lds
v_mfma_f32_32x32x16_bf16 v[24:39], v[192:195], v[148:151], v[24:39]
s_add_u32 s3, s55, 18432
s_mov_b32 m0, s3
s_add_u32 s50, s37, 165888
buffer_load_dwordx4 v222, s[56:59], s50 offen lds
v_mfma_f32_32x32x16_bf16 v[40:55], v[196:199], v[148:151], v[40:55]
s_add_u32 s3, s55, 19456
s_mov_b32 m0, s3
s_add_u32 s50, s37, 175104
buffer_load_dwordx4 v222, s[56:59], s50 offen lds
ds_read_b64_tr_b16 v[184:185], v10 offset:36864
ds_read_b64_tr_b16 v[186:187], v10 offset:37376
ds_read_b64_tr_b16 v[188:189], v11 offset:36864
ds_read_b64_tr_b16 v[190:191], v11 offset:37376
ds_read_b64_tr_b16 v[192:193], v10 offset:38912
ds_read_b64_tr_b16 v[194:195], v10 offset:39424
s_waitcnt lgkmcnt(12)
v_mfma_f32_32x32x16_bf16 v[56:71], v[168:171], v[224:227], 0
ds_read_b64_tr_b16 v[196:197], v11 offset:38912
ds_read_b64_tr_b16 v[198:199], v11 offset:39424
s_waitcnt lgkmcnt(12)
v_mfma_f32_32x32x16_bf16 v[72:87], v[172:175], v[224:227], 0
ds_read_b64_tr_b16 v[168:169], v10 offset:40960
ds_read_b64_tr_b16 v[170:171], v10 offset:41472
s_waitcnt lgkmcnt(12)
v_mfma_f32_32x32x16_bf16 v[56:71], v[176:179], v[228:231], v[56:71]
ds_read_b64_tr_b16 v[172:173], v11 offset:40960
ds_read_b64_tr_b16 v[174:175], v11 offset:41472
s_waitcnt lgkmcnt(12)
v_mfma_f32_32x32x16_bf16 v[72:87], v[180:183], v[228:231], v[72:87]
ds_read_b64_tr_b16 v[176:177], v10 offset:43008
ds_read_b64_tr_b16 v[178:179], v10 offset:43520
s_waitcnt lgkmcnt(12)
v_mfma_f32_32x32x16_bf16 v[56:71], v[184:187], v[232:235], v[56:71]
ds_read_b64_tr_b16 v[180:181], v11 offset:43008
ds_read_b64_tr_b16 v[182:183], v11 offset:43520
s_waitcnt lgkmcnt(12)
v_mfma_f32_32x32x16_bf16 v[72:87], v[188:191], v[232:235], v[72:87]
v_cvt_pk_bf16_f32 v88, v24, v25
v_cvt_pk_bf16_f32 v89, v26, v27
v_cvt_pk_bf16_f32 v90, v28, v29
v_cvt_pk_bf16_f32 v91, v30, v31
v_cvt_pk_bf16_f32 v92, v32, v33
v_cvt_pk_bf16_f32 v93, v34, v35
v_cvt_pk_bf16_f32 v94, v36, v37
v_cvt_pk_bf16_f32 v95, v38, v39
v_cvt_pk_bf16_f32 v96, v40, v41
v_cvt_pk_bf16_f32 v97, v42, v43
v_cvt_pk_bf16_f32 v98, v44, v45
v_cvt_pk_bf16_f32 v99, v46, v47
v_cvt_pk_bf16_f32 v100, v48, v49
v_cvt_pk_bf16_f32 v101, v50, v51
v_cvt_pk_bf16_f32 v102, v52, v53
v_cvt_pk_bf16_f32 v103, v54, v55
s_mul_i32 s61, s53, 20480
s_add_u32 s61, s61, 8192
buffer_store_dwordx4 v[88:91], v1, s[24:27], s61 offen offset:0 sc1
buffer_store_dwordx4 v[92:95], v1, s[24:27], s61 offen offset:1024 sc1
buffer_store_dwordx4 v[96:99], v1, s[24:27], s61 offen offset:2048 sc1
buffer_store_dwordx4 v[100:103], v1, s[24:27], s61 offen offset:3072 sc1
ds_read_b64_tr_b16 v[184:185], v10 offset:45056
ds_read_b64_tr_b16 v[186:187], v10 offset:45568
s_waitcnt lgkmcnt(12)
v_mfma_f32_32x32x16_bf16 v[56:71], v[192:195], v[236:239], v[56:71]
ds_read_b64_tr_b16 v[188:189], v11 offset:45056
ds_read_b64_tr_b16 v[190:191], v11 offset:45568
s_waitcnt lgkmcnt(12)
v_mfma_f32_32x32x16_bf16 v[72:87], v[196:199], v[236:239], v[72:87]
ds_read_b64_tr_b16 v[192:193], v10 offset:47104
ds_read_b64_tr_b16 v[194:195], v10 offset:47616
s_waitcnt lgkmcnt(12)
v_mfma_f32_32x32x16_bf16 v[56:71], v[168:171], v[240:243], v[56:71]
ds_read_b64_tr_b16 v[196:197], v11 offset:47104
ds_read_b64_tr_b16 v[198:199], v11 offset:47616
s_waitcnt lgkmcnt(12)
v_mfma_f32_32x32x16_bf16 v[72:87], v[172:175], v[240:243], v[72:87]
s_waitcnt lgkmcnt(10)
v_mfma_f32_32x32x16_bf16 v[56:71], v[176:179], v[244:247], v[56:71]
s_waitcnt lgkmcnt(8)
v_mfma_f32_32x32x16_bf16 v[72:87], v[180:183], v[244:247], v[72:87]
s_waitcnt lgkmcnt(0)
s_waitcnt vmcnt(16)
s_barrier
ds_read_b64_tr_b16 v[168:169], v10 offset:49152
ds_read_b64_tr_b16 v[170:171], v10 offset:49664
ds_read_b64_tr_b16 v[172:173], v11 offset:49152
ds_read_b64_tr_b16 v[174:175], v11 offset:49664
ds_read_b64_tr_b16 v[176:177], v10 offset:51200
ds_read_b64_tr_b16 v[178:179], v10 offset:51712
v_mfma_f32_32x32x16_bf16 v[56:71], v[184:187], v[248:251], v[56:71]
ds_read_b64_tr_b16 v[180:181], v11 offset:51200
ds_read_b64_tr_b16 v[182:183], v11 offset:51712
v_mfma_f32_32x32x16_bf16 v[72:87], v[188:191], v[248:251], v[72:87]
v_mfma_f32_32x32x16_bf16 v[56:71], v[192:195], v[252:255], v[56:71]
v_mfma_f32_32x32x16_bf16 v[72:87], v[196:199], v[252:255], v[72:87]
ds_read_b64_tr_b16 v[184:185], v10 offset:53248
ds_read_b64_tr_b16 v[186:187], v10 offset:53760
ds_read_b64_tr_b16 v[188:189], v11 offset:53248
ds_read_b64_tr_b16 v[190:191], v11 offset:53760
ds_read_b64_tr_b16 v[192:193], v10 offset:55296
ds_read_b64_tr_b16 v[194:195], v10 offset:55808
s_waitcnt lgkmcnt(12)
v_mfma_f32_32x32x16_bf16 v[56:71], v[168:171], v[120:123], v[56:71]
ds_read_b64_tr_b16 v[196:197], v11 offset:55296
ds_read_b64_tr_b16 v[198:199], v11 offset:55808
s_waitcnt lgkmcnt(12)
v_mfma_f32_32x32x16_bf16 v[72:87], v[172:175], v[120:123], v[72:87]
ds_read_b64_tr_b16 v[168:169], v10 offset:57344
ds_read_b64_tr_b16 v[170:171], v10 offset:57856
s_waitcnt lgkmcnt(12)
v_mfma_f32_32x32x16_bf16 v[56:71], v[176:179], v[124:127], v[56:71]
ds_read_b64_tr_b16 v[172:173], v11 offset:57344
ds_read_b64_tr_b16 v[174:175], v11 offset:57856
s_waitcnt lgkmcnt(12)
v_mfma_f32_32x32x16_bf16 v[72:87], v[180:183], v[124:127], v[72:87]
ds_read_b64_tr_b16 v[176:177], v10 offset:59392
ds_read_b64_tr_b16 v[178:179], v10 offset:59904
s_waitcnt lgkmcnt(12)
v_mfma_f32_32x32x16_bf16 v[56:71], v[184:187], v[128:131], v[56:71]
ds_read_b64_tr_b16 v[180:181], v11 offset:59392
ds_read_b64_tr_b16 v[182:183], v11 offset:59904
s_waitcnt lgkmcnt(12)
v_mfma_f32_32x32x16_bf16 v[72:87], v[188:191], v[128:131], v[72:87]
ds_read_b64_tr_b16 v[184:185], v10 offset:61440
ds_read_b64_tr_b16 v[186:187], v10 offset:61952
s_waitcnt lgkmcnt(12)
v_mfma_f32_32x32x16_bf16 v[56:71], v[192:195], v[132:135], v[56:71]
ds_read_b64_tr_b16 v[188:189], v11 offset:61440
ds_read_b64_tr_b16 v[190:191], v11 offset:61952
s_waitcnt lgkmcnt(12)
v_mfma_f32_32x32x16_bf16 v[72:87], v[196:199], v[132:135], v[72:87]
ds_read_b64_tr_b16 v[192:193], v10 offset:63488
ds_read_b64_tr_b16 v[194:195], v10 offset:64000
s_waitcnt lgkmcnt(12)
v_mfma_f32_32x32x16_bf16 v[56:71], v[168:171], v[136:139], v[56:71]
ds_read_b64_tr_b16 v[196:197], v11 offset:63488
ds_read_b64_tr_b16 v[198:199], v11 offset:64000
s_waitcnt lgkmcnt(12)
v_mfma_f32_32x32x16_bf16 v[72:87], v[172:175], v[136:139], v[72:87]
s_waitcnt lgkmcnt(10)
v_mfma_f32_32x32x16_bf16 v[56:71], v[176:179], v[140:143], v[56:71]
s_waitcnt lgkmcnt(8)
v_mfma_f32_32x32x16_bf16 v[72:87], v[180:183], v[140:143], v[72:87]
s_waitcnt lgkmcnt(0)
s_waitcnt vmcnt(8)
s_barrier
ds_read_b64_tr_b16 v[168:169], v12 offset:0
ds_read_b64_tr_b16 v[170:171], v12 offset:512
ds_read_b64_tr_b16 v[172:173], v12 offset:2048
ds_read_b64_tr_b16 v[174:175], v12 offset:2560
ds_read_b64_tr_b16 v[176:177], v12 offset:4096
ds_read_b64_tr_b16 v[178:179], v12 offset:4608
v_mfma_f32_32x32x16_bf16 v[56:71], v[184:187], v[144:147], v[56:71]
ds_read_b64_tr_b16 v[180:181], v12 offset:6144
ds_read_b64_tr_b16 v[182:183], v12 offset:6656
v_mfma_f32_32x32x16_bf16 v[72:87], v[188:191], v[144:147], v[72:87]
v_mfma_f32_32x32x16_bf16 v[56:71], v[192:195], v[148:151], v[56:71]
v_mfma_f32_32x32x16_bf16 v[72:87], v[196:199], v[148:151], v[72:87]
ds_read_b64_tr_b16 v[184:185], v12 offset:8192
ds_read_b64_tr_b16 v[186:187], v12 offset:8704
ds_read_b64_tr_b16 v[188:189], v12 offset:10240
ds_read_b64_tr_b16 v[190:191], v12 offset:10752
ds_read_b64_tr_b16 v[192:193], v12 offset:12288
ds_read_b64_tr_b16 v[194:195], v12 offset:12800
s_waitcnt lgkmcnt(12)
v_mfma_f32_32x32x16_bf16 v[24:39], v[168:171], v[224:227], 0
ds_read_b64_tr_b16 v[196:197], v12 offset:14336
ds_read_b64_tr_b16 v[198:199], v12 offset:14848
s_waitcnt lgkmcnt(12)
v_mfma_f32_32x32x16_bf16 v[24:39], v[172:175], v[228:231], v[24:39]
s_waitcnt lgkmcnt(10)
v_mfma_f32_32x32x16_bf16 v[24:39], v[176:179], v[232:235], v[24:39]
v_cvt_pk_bf16_f32 v88, v56, v57
v_cvt_pk_bf16_f32 v89, v58, v59
v_cvt_pk_bf16_f32 v90, v60, v61
v_cvt_pk_bf16_f32 v91, v62, v63
v_cvt_pk_bf16_f32 v92, v64, v65
v_cvt_pk_bf16_f32 v93, v66, v67
v_cvt_pk_bf16_f32 v94, v68, v69
v_cvt_pk_bf16_f32 v95, v70, v71
v_cvt_pk_bf16_f32 v96, v72, v73
v_cvt_pk_bf16_f32 v97, v74, v75
v_cvt_pk_bf16_f32 v98, v76, v77
v_cvt_pk_bf16_f32 v99, v78, v79
v_cvt_pk_bf16_f32 v100, v80, v81
v_cvt_pk_bf16_f32 v101, v82, v83
v_cvt_pk_bf16_f32 v102, v84, v85
v_cvt_pk_bf16_f32 v103, v86, v87
s_mul_i32 s61, s53, 20480
s_add_u32 s61, s61, 12288
buffer_store_dwordx4 v[88:91], v1, s[24:27], s61 offen offset:0 sc1
buffer_store_dwordx4 v[92:95], v1, s[24:27], s61 offen offset:1024 sc1
buffer_store_dwordx4 v[96:99], v1, s[24:27], s61 offen offset:2048 sc1
buffer_store_dwordx4 v[100:103], v1, s[24:27], s61 offen offset:3072 sc1
s_waitcnt lgkmcnt(8)
v_mfma_f32_32x32x16_bf16 v[24:39], v[180:183], v[236:239], v[24:39]
s_waitcnt lgkmcnt(0)
s_waitcnt vmcnt(8)
s_barrier
ds_read_b64_tr_b16 v[168:169], v12 offset:16384
ds_read_b64_tr_b16 v[170:171], v12 offset:16896
ds_read_b64_tr_b16 v[172:173], v12 offset:18432
ds_read_b64_tr_b16 v[174:175], v12 offset:18944
ds_read_b64_tr_b16 v[176:177], v12 offset:20480
ds_read_b64_tr_b16 v[178:179], v12 offset:20992
v_mfma_f32_32x32x16_bf16 v[24:39], v[184:187], v[240:243], v[24:39]
ds_read_b64_tr_b16 v[180:181], v12 offset:22528
ds_read_b64_tr_b16 v[182:183], v12 offset:23040
v_mfma_f32_32x32x16_bf16 v[24:39], v[188:191], v[244:247], v[24:39]
v_mfma_f32_32x32x16_bf16 v[24:39], v[192:195], v[248:251], v[24:39]
v_mfma_f32_32x32x16_bf16 v[24:39], v[196:199], v[252:255], v[24:39]
ds_read_b64_tr_b16 v[184:185], v12 offset:24576
ds_read_b64_tr_b16 v[186:187], v12 offset:25088
ds_read_b64_tr_b16 v[188:189], v12 offset:26624
ds_read_b64_tr_b16 v[190:191], v12 offset:27136
ds_read_b64_tr_b16 v[192:193], v12 offset:28672
ds_read_b64_tr_b16 v[194:195], v12 offset:29184
s_waitcnt lgkmcnt(12)
v_mfma_f32_32x32x16_bf16 v[24:39], v[168:171], v[120:123], v[24:39]
ds_read_b64_tr_b16 v[196:197], v12 offset:30720
ds_read_b64_tr_b16 v[198:199], v12 offset:31232
s_waitcnt lgkmcnt(12)
v_mfma_f32_32x32x16_bf16 v[24:39], v[172:175], v[124:127], v[24:39]
s_waitcnt lgkmcnt(10)
v_mfma_f32_32x32x16_bf16 v[24:39], v[176:179], v[128:131], v[24:39]
s_waitcnt lgkmcnt(8)
v_mfma_f32_32x32x16_bf16 v[24:39], v[180:183], v[132:135], v[24:39]
s_waitcnt lgkmcnt(6)
v_mfma_f32_32x32x16_bf16 v[24:39], v[184:187], v[136:139], v[24:39]
s_waitcnt lgkmcnt(4)
v_mfma_f32_32x32x16_bf16 v[24:39], v[188:191], v[140:143], v[24:39]
s_waitcnt lgkmcnt(2)
v_mfma_f32_32x32x16_bf16 v[24:39], v[192:195], v[144:147], v[24:39]
s_waitcnt lgkmcnt(0)
v_mfma_f32_32x32x16_bf16 v[24:39], v[196:199], v[148:151], v[24:39]
s_nop 15
v_cvt_pk_bf16_f32 v88, v24, v25
v_cvt_pk_bf16_f32 v89, v26, v27
v_cvt_pk_bf16_f32 v90, v28, v29
v_cvt_pk_bf16_f32 v91, v30, v31
v_cvt_pk_bf16_f32 v92, v32, v33
v_cvt_pk_bf16_f32 v93, v34, v35
v_cvt_pk_bf16_f32 v94, v36, v37
v_cvt_pk_bf16_f32 v95, v38, v39
s_lshl_b32 s61, s53, 11
s_add_u32 s61, s61, 16384
buffer_store_dwordx4 v[88:91], v1, s[24:27], s61 offen offset:0 sc1
buffer_store_dwordx4 v[92:95], v1, s[24:27], s61 offen offset:1024 sc1
s_waitcnt vmcnt(0)
L_attn_done:
s_endpgm
.globl reduce_kernel
.p2align 8
.type reduce_kernel,@function
reduce_kernel:
s_cmp_ge_u32 s2, 576
s_cbranch_scc1 L_rd_done
s_load_dwordx2 s[38:39], s[0:1], 96
s_load_dwordx2 s[36:37], s[0:1], 80
v_lshrrev_b32 v1, 6, v0
v_and_b32 v0, 63, v0
s_nop 0
v_readfirstlane_b32 s7, v1
s_nop 3
s_lshl_b32 s3, s2, 2
s_add_u32 s3, s3, s7
s_mul_i32 s4, s3, 58255
s_lshr_b32 s4, s4, 23
s_mul_i32 s5, s4, 144
s_sub_u32 s5, s3, s5
s_mul_i32 s6, s5, 1821
s_lshr_b32 s6, s6, 16
s_mul_i32 s8, s6, 36
s_sub_u32 s8, s5, s8
v_lshlrev_b32 v1, 4, v0
s_waitcnt lgkmcnt(0)
s_mul_i32 s9, s4, 2359296
s_lshl_b32 s10, s5, 10
s_add_u32 s9, s9, s10
s_add_u32 s12, s38, s9
s_addc_u32 s13, s39, 0
s_and_b32 s13, s13, 0xffff
s_mov_b32 s14, 2359296
s_mov_b32 s15, 0x20000
s_mov_b32 s16, s36
s_and_b32 s17, s37, 0xffff
s_mov_b32 s18, 2359296
s_mov_b32 s19, 0x20000
s_mov_b32 s20, 0
buffer_load_dwordx4 v[8:11], v1, s[12:15], s20 offen
s_mov_b32 s20, 147456
buffer_load_dwordx4 v[12:15], v1, s[12:15], s20 offen
s_mov_b32 s20, 294912
buffer_load_dwordx4 v[16:19], v1, s[12:15], s20 offen
s_mov_b32 s20, 442368
buffer_load_dwordx4 v[20:23], v1, s[12:15], s20 offen
s_mov_b32 s20, 589824
buffer_load_dwordx4 v[24:27], v1, s[12:15], s20 offen
s_mov_b32 s20, 737280
buffer_load_dwordx4 v[28:31], v1, s[12:15], s20 offen
s_mov_b32 s20, 884736
buffer_load_dwordx4 v[32:35], v1, s[12:15], s20 offen
s_mov_b32 s20, 1032192
buffer_load_dwordx4 v[36:39], v1, s[12:15], s20 offen
s_mov_b32 s20, 1179648
buffer_load_dwordx4 v[40:43], v1, s[12:15], s20 offen
s_mov_b32 s20, 1327104
buffer_load_dwordx4 v[44:47], v1, s[12:15], s20 offen
s_mov_b32 s20, 1474560
buffer_load_dwordx4 v[48:51], v1, s[12:15], s20 offen
s_mov_b32 s20, 1622016
buffer_load_dwordx4 v[52:55], v1, s[12:15], s20 offen
s_mov_b32 s20, 1769472
buffer_load_dwordx4 v[56:59], v1, s[12:15], s20 offen
s_mov_b32 s20, 1916928
buffer_load_dwordx4 v[60:63], v1, s[12:15], s20 offen
s_mov_b32 s20, 2064384
buffer_load_dwordx4 v[64:67], v1, s[12:15], s20 offen
s_mov_b32 s20, 2211840
buffer_load_dwordx4 v[68:71], v1, s[12:15], s20 offen
s_and_b32 s9, s4, 7
s_lshr_b32 s10, s4, 3
s_lshl_b32 s9, s9, 7
s_lshl_b32 s11, s6, 5
s_add_u32 s9, s9, s11
v_and_b32 v2, 31, v0
v_add_u32 v2, s9, v2
v_mul_u32_u24 v2, 2304, v2
v_lshrrev_b32 v3, 5, v0
v_lshl_add_u32 v2, v3, 4, v2
s_mul_i32 s10, s10, 1152
s_lshl_b32 s11, s8, 5
s_add_u32 s10, s10, s11
v_add_u32 v2, s10, v2
s_waitcnt vmcnt(15)
v_lshlrev_b32 v80, 16, v8
v_and_b32 v81, 0xffff0000, v8
v_lshlrev_b32 v82, 16, v9
v_and_b32 v83, 0xffff0000, v9
v_lshlrev_b32 v84, 16, v10
v_and_b32 v85, 0xffff0000, v10
v_lshlrev_b32 v86, 16, v11
v_and_b32 v87, 0xffff0000, v11
s_waitcnt vmcnt(14)
v_lshlrev_b32 v88, 16, v12
v_and_b32 v89, 0xffff0000, v12
v_lshlrev_b32 v90, 16, v13
v_and_b32 v91, 0xffff0000, v13
v_lshlrev_b32 v92, 16, v14
v_and_b32 v93, 0xffff0000, v14
v_lshlrev_b32 v94, 16, v15
v_and_b32 v95, 0xffff0000, v15
v_add_f32 v80, v80, v88
v_add_f32 v81, v81, v89
v_add_f32 v82, v82, v90
v_add_f32 v83, v83, v91
v_add_f32 v84, v84, v92
v_add_f32 v85, v85, v93
v_add_f32 v86, v86, v94
v_add_f32 v87, v87, v95
s_waitcnt vmcnt(13)
v_lshlrev_b32 v88, 16, v16
v_and_b32 v89, 0xffff0000, v16
v_lshlrev_b32 v90, 16, v17
v_and_b32 v91, 0xffff0000, v17
v_lshlrev_b32 v92, 16, v18
v_and_b32 v93, 0xffff0000, v18
v_lshlrev_b32 v94, 16, v19
v_and_b32 v95, 0xffff0000, v19
v_add_f32 v80, v80, v88
v_add_f32 v81, v81, v89
v_add_f32 v82, v82, v90
v_add_f32 v83, v83, v91
v_add_f32 v84, v84, v92
v_add_f32 v85, v85, v93
v_add_f32 v86, v86, v94
v_add_f32 v87, v87, v95
s_waitcnt vmcnt(12)
v_lshlrev_b32 v88, 16, v20
v_and_b32 v89, 0xffff0000, v20
v_lshlrev_b32 v90, 16, v21
v_and_b32 v91, 0xffff0000, v21
v_lshlrev_b32 v92, 16, v22
v_and_b32 v93, 0xffff0000, v22
v_lshlrev_b32 v94, 16, v23
v_and_b32 v95, 0xffff0000, v23
v_add_f32 v80, v80, v88
v_add_f32 v81, v81, v89
v_add_f32 v82, v82, v90
v_add_f32 v83, v83, v91
v_add_f32 v84, v84, v92
v_add_f32 v85, v85, v93
v_add_f32 v86, v86, v94
v_add_f32 v87, v87, v95
s_waitcnt vmcnt(11)
v_lshlrev_b32 v88, 16, v24
v_and_b32 v89, 0xffff0000, v24
v_lshlrev_b32 v90, 16, v25
v_and_b32 v91, 0xffff0000, v25
v_lshlrev_b32 v92, 16, v26
v_and_b32 v93, 0xffff0000, v26
v_lshlrev_b32 v94, 16, v27
v_and_b32 v95, 0xffff0000, v27
v_add_f32 v80, v80, v88
v_add_f32 v81, v81, v89
v_add_f32 v82, v82, v90
v_add_f32 v83, v83, v91
v_add_f32 v84, v84, v92
v_add_f32 v85, v85, v93
v_add_f32 v86, v86, v94
v_add_f32 v87, v87, v95
s_waitcnt vmcnt(10)
v_lshlrev_b32 v88, 16, v28
v_and_b32 v89, 0xffff0000, v28
v_lshlrev_b32 v90, 16, v29
v_and_b32 v91, 0xffff0000, v29
v_lshlrev_b32 v92, 16, v30
v_and_b32 v93, 0xffff0000, v30
v_lshlrev_b32 v94, 16, v31
v_and_b32 v95, 0xffff0000, v31
v_add_f32 v80, v80, v88
v_add_f32 v81, v81, v89
v_add_f32 v82, v82, v90
v_add_f32 v83, v83, v91
v_add_f32 v84, v84, v92
v_add_f32 v85, v85, v93
v_add_f32 v86, v86, v94
v_add_f32 v87, v87, v95
s_waitcnt vmcnt(9)
v_lshlrev_b32 v88, 16, v32
v_and_b32 v89, 0xffff0000, v32
v_lshlrev_b32 v90, 16, v33
v_and_b32 v91, 0xffff0000, v33
v_lshlrev_b32 v92, 16, v34
v_and_b32 v93, 0xffff0000, v34
v_lshlrev_b32 v94, 16, v35
v_and_b32 v95, 0xffff0000, v35
v_add_f32 v80, v80, v88
v_add_f32 v81, v81, v89
v_add_f32 v82, v82, v90
v_add_f32 v83, v83, v91
v_add_f32 v84, v84, v92
v_add_f32 v85, v85, v93
v_add_f32 v86, v86, v94
v_add_f32 v87, v87, v95
s_waitcnt vmcnt(8)
v_lshlrev_b32 v88, 16, v36
v_and_b32 v89, 0xffff0000, v36
v_lshlrev_b32 v90, 16, v37
v_and_b32 v91, 0xffff0000, v37
v_lshlrev_b32 v92, 16, v38
v_and_b32 v93, 0xffff0000, v38
v_lshlrev_b32 v94, 16, v39
v_and_b32 v95, 0xffff0000, v39
v_add_f32 v80, v80, v88
v_add_f32 v81, v81, v89
v_add_f32 v82, v82, v90
v_add_f32 v83, v83, v91
v_add_f32 v84, v84, v92
v_add_f32 v85, v85, v93
v_add_f32 v86, v86, v94
v_add_f32 v87, v87, v95
s_waitcnt vmcnt(7)
v_lshlrev_b32 v88, 16, v40
v_and_b32 v89, 0xffff0000, v40
v_lshlrev_b32 v90, 16, v41
v_and_b32 v91, 0xffff0000, v41
v_lshlrev_b32 v92, 16, v42
v_and_b32 v93, 0xffff0000, v42
v_lshlrev_b32 v94, 16, v43
v_and_b32 v95, 0xffff0000, v43
v_add_f32 v80, v80, v88
v_add_f32 v81, v81, v89
v_add_f32 v82, v82, v90
v_add_f32 v83, v83, v91
v_add_f32 v84, v84, v92
v_add_f32 v85, v85, v93
v_add_f32 v86, v86, v94
v_add_f32 v87, v87, v95
s_waitcnt vmcnt(6)
v_lshlrev_b32 v88, 16, v44
v_and_b32 v89, 0xffff0000, v44
v_lshlrev_b32 v90, 16, v45
v_and_b32 v91, 0xffff0000, v45
v_lshlrev_b32 v92, 16, v46
v_and_b32 v93, 0xffff0000, v46
v_lshlrev_b32 v94, 16, v47
v_and_b32 v95, 0xffff0000, v47
v_add_f32 v80, v80, v88
v_add_f32 v81, v81, v89
v_add_f32 v82, v82, v90
v_add_f32 v83, v83, v91
v_add_f32 v84, v84, v92
v_add_f32 v85, v85, v93
v_add_f32 v86, v86, v94
v_add_f32 v87, v87, v95
s_waitcnt vmcnt(5)
v_lshlrev_b32 v88, 16, v48
v_and_b32 v89, 0xffff0000, v48
v_lshlrev_b32 v90, 16, v49
v_and_b32 v91, 0xffff0000, v49
v_lshlrev_b32 v92, 16, v50
v_and_b32 v93, 0xffff0000, v50
v_lshlrev_b32 v94, 16, v51
v_and_b32 v95, 0xffff0000, v51
v_add_f32 v80, v80, v88
v_add_f32 v81, v81, v89
v_add_f32 v82, v82, v90
v_add_f32 v83, v83, v91
v_add_f32 v84, v84, v92
v_add_f32 v85, v85, v93
v_add_f32 v86, v86, v94
v_add_f32 v87, v87, v95
s_waitcnt vmcnt(4)
v_lshlrev_b32 v88, 16, v52
v_and_b32 v89, 0xffff0000, v52
v_lshlrev_b32 v90, 16, v53
v_and_b32 v91, 0xffff0000, v53
v_lshlrev_b32 v92, 16, v54
v_and_b32 v93, 0xffff0000, v54
v_lshlrev_b32 v94, 16, v55
v_and_b32 v95, 0xffff0000, v55
v_add_f32 v80, v80, v88
v_add_f32 v81, v81, v89
v_add_f32 v82, v82, v90
v_add_f32 v83, v83, v91
v_add_f32 v84, v84, v92
v_add_f32 v85, v85, v93
v_add_f32 v86, v86, v94
v_add_f32 v87, v87, v95
s_waitcnt vmcnt(3)
v_lshlrev_b32 v88, 16, v56
v_and_b32 v89, 0xffff0000, v56
v_lshlrev_b32 v90, 16, v57
v_and_b32 v91, 0xffff0000, v57
v_lshlrev_b32 v92, 16, v58
v_and_b32 v93, 0xffff0000, v58
v_lshlrev_b32 v94, 16, v59
v_and_b32 v95, 0xffff0000, v59
v_add_f32 v80, v80, v88
v_add_f32 v81, v81, v89
v_add_f32 v82, v82, v90
v_add_f32 v83, v83, v91
v_add_f32 v84, v84, v92
v_add_f32 v85, v85, v93
v_add_f32 v86, v86, v94
v_add_f32 v87, v87, v95
s_waitcnt vmcnt(2)
v_lshlrev_b32 v88, 16, v60
v_and_b32 v89, 0xffff0000, v60
v_lshlrev_b32 v90, 16, v61
v_and_b32 v91, 0xffff0000, v61
v_lshlrev_b32 v92, 16, v62
v_and_b32 v93, 0xffff0000, v62
v_lshlrev_b32 v94, 16, v63
v_and_b32 v95, 0xffff0000, v63
v_add_f32 v80, v80, v88
v_add_f32 v81, v81, v89
v_add_f32 v82, v82, v90
v_add_f32 v83, v83, v91
v_add_f32 v84, v84, v92
v_add_f32 v85, v85, v93
v_add_f32 v86, v86, v94
v_add_f32 v87, v87, v95
s_waitcnt vmcnt(1)
v_lshlrev_b32 v88, 16, v64
v_and_b32 v89, 0xffff0000, v64
v_lshlrev_b32 v90, 16, v65
v_and_b32 v91, 0xffff0000, v65
v_lshlrev_b32 v92, 16, v66
v_and_b32 v93, 0xffff0000, v66
v_lshlrev_b32 v94, 16, v67
v_and_b32 v95, 0xffff0000, v67
v_add_f32 v80, v80, v88
v_add_f32 v81, v81, v89
v_add_f32 v82, v82, v90
v_add_f32 v83, v83, v91
v_add_f32 v84, v84, v92
v_add_f32 v85, v85, v93
v_add_f32 v86, v86, v94
v_add_f32 v87, v87, v95
s_waitcnt vmcnt(0)
v_lshlrev_b32 v88, 16, v68
v_and_b32 v89, 0xffff0000, v68
v_lshlrev_b32 v90, 16, v69
v_and_b32 v91, 0xffff0000, v69
v_lshlrev_b32 v92, 16, v70
v_and_b32 v93, 0xffff0000, v70
v_lshlrev_b32 v94, 16, v71
v_and_b32 v95, 0xffff0000, v71
v_add_f32 v80, v80, v88
v_add_f32 v81, v81, v89
v_add_f32 v82, v82, v90
v_add_f32 v83, v83, v91
v_add_f32 v84, v84, v92
v_add_f32 v85, v85, v93
v_add_f32 v86, v86, v94
v_add_f32 v87, v87, v95
v_cvt_pk_bf16_f32 v4, v80, v81
v_cvt_pk_bf16_f32 v5, v82, v83
v_cvt_pk_bf16_f32 v6, v84, v85
v_cvt_pk_bf16_f32 v7, v86, v87
s_nop 1
v_permlane32_swap_b32 v4, v6
v_permlane32_swap_b32 v5, v7
buffer_store_dwordx4 v[4:7], v2, s[16:19], 0 offen
s_waitcnt vmcnt(0)
L_rd_done:
s_endpgm
.section .rodata,"a"
.p2align 6
.amdhsa_kernel attn_kernel
  .amdhsa_next_free_vgpr 256
  .amdhsa_next_free_sgpr 64
  .amdhsa_accum_offset 256
  .amdhsa_group_segment_fixed_size 0
  .amdhsa_kernarg_size 104
  .amdhsa_user_sgpr_count 2
  .amdhsa_user_sgpr_kernarg_segment_ptr 1
  .amdhsa_system_sgpr_workgroup_id_x 1
.end_amdhsa_kernel
.p2align 6
.amdhsa_kernel reduce_kernel
  .amdhsa_next_free_vgpr 96
  .amdhsa_next_free_sgpr 64
  .amdhsa_accum_offset 96
  .amdhsa_group_segment_fixed_size 0
  .amdhsa_kernarg_size 104
  .amdhsa_user_sgpr_count 2
  .amdhsa_user_sgpr_kernarg_segment_ptr 1
  .amdhsa_system_sgpr_workgroup_id_x 1
.end_amdhsa_kernel
```
